```python
import torch

def _softmax(x, axis=-1):
    return torch.softmax(x, dim=axis)
def _gelu(x):
    return torch.nn.functional.gelu(x, approximate="tanh")
def _silu(x):
    return torch.nn.functional.silu(x)
def _sigmoid(x):
    return torch.sigmoid(x)
def _layernorm(x, axis=-1, eps=1e-5):
    m = x.mean(dim=axis, keepdim=True)
    v = x.var(dim=axis, keepdim=True, unbiased=False)
    return (x - m) / torch.sqrt(v + eps)
def _scatter_add(tgt, idx, src, axis=0):
    return tgt.clone().index_add_(axis, idx, src)
def _segment_sum(src, seg, n):
    out = torch.zeros((n,) + src.shape[1:], dtype=src.dtype)
    return out.index_add_(0, seg, src)
def _pad(x, pw):
    flat = tuple(v for pair in reversed(pw) for v in pair)
    return torch.nn.functional.pad(x, flat)

kernel_name = 'standalone__paged_block_table_kv_radixattention__sampling'

def setup_inputs():

    _w = (lambda a: (lambda t: t.to(torch.bfloat16) if t.is_floating_point() else t)(torch.as_tensor(a)))
    B, H, Hkv, Dh = 16, 32, 16, 128
    Lk = 4096
    bs = 16
    nb = max(2, Lk // bs)
    P = max(1, nb // 2)
    n_phys = P + B * (nb - P)
    shared = torch.arange(P, dtype=torch.int64)
    priv = P + torch.arange(B * (nb - P), dtype=torch.int64).reshape(B, nb - P)
    bt = torch.cat([torch.tile(shared[None, :], (B, 1)), priv], dim=1)
    ctx = nb * bs - (torch.arange(1, B + 1, dtype=torch.int64) * 2654435761) % max(1, (nb * bs - P * bs) // 2)
    return {
        "q": _w((lambda *s: torch.randn(*s, dtype=torch.bfloat16) * 0.8)(B, H, Dh)),
        "k_cache": _w((lambda *s: torch.randn(*s, dtype=torch.bfloat16) * 0.8)(n_phys, bs, Hkv, Dh)),
        "v_cache": _w((lambda *s: torch.randn(*s, dtype=torch.bfloat16) * 0.05)(n_phys, bs, Hkv, Dh)),
        "block_table": _w(bt.to(torch.int64)),
        "ctx_lens": _w(torch.as_tensor(ctx).to(torch.int64)),
    }

def reference(q, k_cache, v_cache, block_table, ctx_lens):
    B, H, Dh = q.shape
    n_phys, bs, Hkv, _ = k_cache.shape
    nb = block_table.shape[1]
    Lk = nb * bs
    rep = H // Hkv
    k = k_cache[block_table].reshape(B, Lk, Hkv, Dh)
    v = v_cache[block_table].reshape(B, Lk, Hkv, Dh)
    k = (lambda x, n, axis: torch.repeat_interleave(x, n, dim=axis))(k, rep, axis=2)
    v = (lambda x, n, axis: torch.repeat_interleave(x, n, dim=axis))(v, rep, axis=2)
    scores = torch.einsum("bhd,bkhd->bhk", q, k) * (Dh ** -0.5)
    pos = torch.arange(Lk)
    valid = pos[None, :] < ctx_lens[:, None]
    scores = torch.where(valid[:, None, :], scores, -1e9)
    p = _softmax(scores, axis=-1)
    return torch.einsum("bhk,bkhd->bhd", p, v)
```

```asm
; @launch grid=(256,1,1) block=(384,1,1) lds=154112
.amdgcn_target "amdgcn-amd-amdhsa--gfx950"
.text
.globl standalone__paged_block_table_kv_radixattention__sampling_kernel
.p2align 8
.type standalone__paged_block_table_kv_radixattention__sampling_kernel,@function
standalone__paged_block_table_kv_radixattention__sampling_kernel:
    s_cmp_ge_u32 s2, 256
    s_cbranch_scc1 L_exit
    s_load_dwordx16 s[16:31], s[0:1], 0
    v_lshrrev_b32 v2, 6, v0
    v_and_b32 v1, 63, v0
    v_readfirstlane_b32 s3, v2
    s_mov_b32 s9, 0x40000
    s_and_b32 s5, s2, 15
    s_lshr_b32 s4, s2, 4
    s_cmp_eq_u32 s3, 4
    s_cbranch_scc1 L_sched
    s_cmp_eq_u32 s3, 5
    s_cbranch_scc1 L_red
    s_add_u32 s3, s3, 2
    s_and_b32 s3, s3, 3
L_stream:
    v_and_b32 v2, 15, v1
    v_lshrrev_b32 v3, 4, v1
    v_lshlrev_b32 v28, 4, v1
    v_and_b32 v29, 1, v1
    v_lshlrev_b32 v29, 8, v29
    v_lshl_add_u32 v25, v3, 4, v29
    v_add_u32 v29, 0, v3
    v_xor_b32 v30, v29, v2
    v_lshlrev_b32 v30, 4, v30
    v_lshl_add_u32 v4, v29, 12, v30
    v_add_u32 v29, 4, v3
    v_xor_b32 v30, v29, v2
    v_lshlrev_b32 v30, 4, v30
    v_lshl_add_u32 v5, v29, 12, v30
    v_subrev_u32 v5, 1024, v5
    v_add_u32 v29, 8, v3
    v_xor_b32 v30, v29, v2
    v_lshlrev_b32 v30, 4, v30
    v_lshl_add_u32 v6, v29, 12, v30
    v_subrev_u32 v6, 2048, v6
    v_add_u32 v29, 12, v3
    v_xor_b32 v30, v29, v2
    v_lshlrev_b32 v30, 4, v30
    v_lshl_add_u32 v7, v29, 12, v30
    v_subrev_u32 v7, 3072, v7
    v_lshlrev_b32 v29, 14, v3
    v_lshl_add_u32 v8, v2, 4, v29
    v_add_u32 v9, 0x1000, v8
    v_add_u32 v10, 0x2000, v8
    v_add_u32 v11, 0x3000, v8
    s_lshl_b32 s57, s3, 13
    s_add_u32 s60, s4, 1
    s_mul_i32 s60, s60, 433
    s_and_b32 s60, s60, 1023
    s_sub_u32 s60, 4096, s60
    s_sub_u32 s61, s60, 1
    s_lshr_b32 s61, s61, 6
    s_lshl2_add_u32 s61, s61, s3
    s_lshl_b32 s62, s61, 4
    s_lshl_b32 s63, s4, 7
    s_add_u32 s61, s61, s63
    s_lshl_b32 s61, s61, 16
    s_lshl_b32 s63, s5, 8
    s_add_u32 s61, s61, s63
    s_cmp_lt_u32 s62, s60
    s_cselect_b32 s68, s61, 2147483648
    s_sub_u32 s69, s61, 0x40000
    s_lshl_b32 s60, s4, 10
    s_lshl2_add_u32 s60, s3, s60
    s_lshl_b32 s61, s4, 2
    s_lshl_b32 s62, s4, 13
    s_lshl_b32 s63, s5, 9
    s_add_u32 s62, s62, s63
    s_mov_b32 s42, 16384
    s_mov_b32 s43, 0x20000
    s_mov_b32 s46, 131072
    s_mov_b32 s47, 0x20000
    s_mov_b32 s34, 142606336
    s_mov_b32 s35, 0x20000
    s_mov_b32 s38, 142606336
    s_mov_b32 s39, 0x20000
    s_waitcnt lgkmcnt(0)
    s_load_dword s66, s[24:25], s61
    s_mov_b64 s[40:41], s[22:23]
    s_mov_b64 s[32:33], s[18:19]
    s_mov_b64 s[36:37], s[20:21]
    s_mov_b64 s[44:45], s[16:17]
    buffer_load_dword v31, v28, s[40:43], s60 offen
    s_mov_b32 s50, s68
    s_add_u32 m0, s57, 0
    s_nop 0
    buffer_load_dwordx4 v4, s[32:35], s50 offen offset:0 nt lds
    buffer_load_dwordx4 v5, s[32:35], s50 offen offset:1024 nt lds
    buffer_load_dwordx4 v6, s[32:35], s50 offen offset:2048 nt lds
    buffer_load_dwordx4 v7, s[32:35], s50 offen offset:3072 nt lds
    buffer_load_dwordx4 v[56:59], v25, s[44:47], s62 offen offset:0
    buffer_load_dwordx4 v[60:63], v25, s[44:47], s62 offen offset:64
    buffer_load_dwordx4 v[64:67], v25, s[44:47], s62 offen offset:128
    buffer_load_dwordx4 v[68:71], v25, s[44:47], s62 offen offset:192
    buffer_load_dwordx4 v[136:139], v8, s[36:39], s50 offen nt
    buffer_load_dwordx4 v[140:143], v9, s[36:39], s50 offen nt
    buffer_load_dwordx4 v[144:147], v10, s[36:39], s50 offen nt
    buffer_load_dwordx4 v[148:151], v11, s[36:39], s50 offen nt
    s_mov_b32 s50, s69
    s_add_u32 m0, s57, 4096
    s_nop 0
    buffer_load_dwordx4 v4, s[32:35], s50 offen offset:0 nt lds
    buffer_load_dwordx4 v5, s[32:35], s50 offen offset:1024 nt lds
    buffer_load_dwordx4 v6, s[32:35], s50 offen offset:2048 nt lds
    buffer_load_dwordx4 v7, s[32:35], s50 offen offset:3072 nt lds
    v_add_u32 v29, 0, v3
    v_xor_b32 v29, v29, v2
    v_lshlrev_b32 v29, 4, v29
    v_lshl_add_u32 v29, v2, 8, v29
    v_add_u32 v12, s57, v29
    v_add_u32 v29, 4, v3
    v_xor_b32 v29, v29, v2
    v_lshlrev_b32 v29, 4, v29
    v_lshl_add_u32 v29, v2, 8, v29
    v_add_u32 v13, s57, v29
    v_add_u32 v29, 8, v3
    v_xor_b32 v29, v29, v2
    v_lshlrev_b32 v29, 4, v29
    v_lshl_add_u32 v29, v2, 8, v29
    v_add_u32 v14, s57, v29
    v_add_u32 v29, 12, v3
    v_xor_b32 v29, v29, v2
    v_lshlrev_b32 v29, 4, v29
    v_lshl_add_u32 v29, v2, 8, v29
    v_add_u32 v15, s57, v29
    v_mov_b32 v29, 0xffff
    v_and_b32 v30, 2, v2
    v_lshlrev_b32 v30, 3, v30
    v_lshlrev_b32 v29, v30, v29
    v_lshrrev_b32 v30, 2, v2
    v_cmp_eq_u32 vcc, 0, v30
    s_nop 1
    v_cndmask_b32 v16, 0, v29, vcc
    v_cmp_eq_u32 vcc, 1, v30
    s_nop 1
    v_cndmask_b32 v17, 0, v29, vcc
    v_cmp_eq_u32 vcc, 2, v30
    s_nop 1
    v_cndmask_b32 v18, 0, v29, vcc
    v_cmp_eq_u32 vcc, 3, v30
    s_nop 1
    v_cndmask_b32 v19, 0, v29, vcc
    v_lshlrev_b32 v20, 2, v3
    s_lshl_b32 s60, s3, 8
    s_add_u32 s60, s60, 61440
    v_lshl_add_u32 v24, v1, 2, s60
    v_add_u32 v25, 49152, v25
    s_mul_i32 s60, s3, 1040
    s_add_u32 s60, s60, 62720
    v_lshl_add_u32 v26, v1, 4, s60
    s_mul_i32 s60, s3, 16640
    s_add_u32 s60, s60, 79360
    v_lshrrev_b32 v29, 1, v2
    v_mul_u32_u24 v29, 1040, v29
    v_lshl_add_u32 v29, v3, 6, v29
    v_and_b32 v30, 1, v2
    v_lshl_add_u32 v29, v30, 2, v29
    v_add_u32 v27, s60, v29
    s_mov_b32 s52, 0
    s_mov_b32 s53, 0x3e0293ee
    s_mov_b32 s54, 0x05040100
    s_mov_b32 s55, 0x07060302
    s_mov_b32 s56, 0xd028965f
    v_mov_b32 v34, 0xff61b1e6
    v_mov_b32 v35, 0
    v_mov_b32 v36, 0xff61b1e6
    v_mov_b32 v38, 0xff61b1e6
    v_mov_b32 v37, 0
    v_mov_b32 v39, 0
    v_mov_b32 v40, 0
    v_mov_b32 v41, 0
    v_mov_b32 v42, 0
    v_mov_b32 v43, 0
    s_barrier
    s_lshl_b32 s63, s5, 8
    s_waitcnt lgkmcnt(0)
    s_max_i32 s60, s66, 0
    s_min_i32 s60, s60, 4096
    s_add_u32 s61, s60, 63
    s_lshr_b32 s61, s61, 6
    s_cmp_eq_u32 s61, 0
    s_cselect_b32 s61, 64, s61
    s_cselect_b32 s64, 1, 0
    s_lshl_b32 s62, s3, 4
    s_sub_i32 s60, s60, s62
    s_lshl_b32 s62, s3, 2
    s_add_u32 s62, s62, 57344
    v_mov_b32 v21, s62
    s_waitcnt vmcnt(16)
    s_sub_i32 s62, s61, 1
    s_max_i32 s51, s62, 0
    v_readlane_b32 s50, v31, s51
    s_lshl_b32 s51, s51, 6
    s_sub_i32 s51, s60, s51
    s_max_i32 s51, s51, 0
    s_min_i32 s51, s51, 16
    s_lshl_b32 s50, s50, 16
    s_add_u32 s50, s50, s63
    s_or_b32 s58, s51, s64
    s_or_b32 s51, s51, 2048
    s_cmp_lt_i32 s62, 0
    s_cselect_b32 s58, 0, s58
    s_cmp_eq_u32 s58, 0
    s_cselect_b32 s50, 2147483648, s50
    s_cselect_b32 s48, 1050688, s51
    s_mov_b32 s70, s50
    s_sub_i32 s62, s61, 2
    s_max_i32 s51, s62, 0
    v_readlane_b32 s50, v31, s51
    s_lshl_b32 s51, s51, 6
    s_sub_i32 s51, s60, s51
    s_max_i32 s51, s51, 0
    s_min_i32 s51, s51, 16
    s_lshl_b32 s50, s50, 16
    s_add_u32 s50, s50, s63
    s_or_b32 s58, s51, s64
    s_or_b32 s51, s51, 2048
    s_cmp_lt_i32 s62, 0
    s_cselect_b32 s58, 0, s58
    s_cmp_eq_u32 s58, 0
    s_cselect_b32 s50, 2147483648, s50
    s_cselect_b32 s49, 1050688, s51
    s_mov_b32 s71, s50
    s_cmp_eq_u64 s[68:69], s[70:71]
    s_cbranch_scc1 L_guess_ok
    s_waitcnt vmcnt(0)
    s_mov_b32 s50, s70
    s_add_u32 m0, s57, 0
    s_nop 0
    buffer_load_dwordx4 v4, s[32:35], s50 offen offset:0 nt lds
    buffer_load_dwordx4 v5, s[32:35], s50 offen offset:1024 nt lds
    buffer_load_dwordx4 v6, s[32:35], s50 offen offset:2048 nt lds
    buffer_load_dwordx4 v7, s[32:35], s50 offen offset:3072 nt lds
    buffer_load_dwordx4 v[136:139], v8, s[36:39], s50 offen nt
    buffer_load_dwordx4 v[140:143], v9, s[36:39], s50 offen nt
    buffer_load_dwordx4 v[144:147], v10, s[36:39], s50 offen nt
    buffer_load_dwordx4 v[148:151], v11, s[36:39], s50 offen nt
    s_mov_b32 s50, s71
    s_add_u32 m0, s57, 4096
    s_nop 0
    buffer_load_dwordx4 v4, s[32:35], s50 offen offset:0 nt lds
    buffer_load_dwordx4 v5, s[32:35], s50 offen offset:1024 nt lds
    buffer_load_dwordx4 v6, s[32:35], s50 offen offset:2048 nt lds
    buffer_load_dwordx4 v7, s[32:35], s50 offen offset:3072 nt lds
L_guess_ok:
    buffer_load_dwordx4 v[152:155], v8, s[36:39], s50 offen nt
    buffer_load_dwordx4 v[156:159], v9, s[36:39], s50 offen nt
    buffer_load_dwordx4 v[160:163], v10, s[36:39], s50 offen nt
    buffer_load_dwordx4 v[164:167], v11, s[36:39], s50 offen nt
    s_sub_i32 s62, s61, 3
    s_max_i32 s51, s62, 0
    v_readlane_b32 s50, v31, s51
    s_lshl_b32 s51, s51, 6
    s_sub_i32 s51, s60, s51
    s_max_i32 s51, s51, 0
    s_min_i32 s51, s51, 16
    s_lshl_b32 s50, s50, 16
    s_add_u32 s50, s50, s63
    s_or_b32 s58, s51, s64
    s_or_b32 s51, s51, 2048
    s_cmp_lt_i32 s62, 0
    s_cselect_b32 s58, 0, s58
    s_cmp_eq_u32 s58, 0
    s_cselect_b32 s50, 2147483648, s50
    s_cselect_b32 s51, 1050688, s51
    v_mov_b32 v29, s50
    v_mov_b32 v30, s51
    ds_write_b32 v21, v29 offset:0
    ds_write_b32 v21, v30 offset:16
    s_sub_i32 s62, s61, 4
    s_max_i32 s51, s62, 0
    v_readlane_b32 s50, v31, s51
    s_lshl_b32 s51, s51, 6
    s_sub_i32 s51, s60, s51
    s_max_i32 s51, s51, 0
    s_min_i32 s51, s51, 16
    s_lshl_b32 s50, s50, 16
    s_add_u32 s50, s50, s63
    s_or_b32 s58, s51, s64
    s_or_b32 s51, s51, 2048
    s_cmp_lt_i32 s62, 0
    s_cselect_b32 s58, 0, s58
    s_cmp_eq_u32 s58, 0
    s_cselect_b32 s50, 2147483648, s50
    s_cselect_b32 s51, 1050688, s51
    v_mov_b32 v29, s50
    v_mov_b32 v30, s51
    ds_write_b32 v21, v29 offset:32
    ds_write_b32 v21, v30 offset:48
L_it0:
    ds_read_b32 v22, v21 offset:16
    ds_read_b32 v23, v21
    s_mov_b32 s58, 0
    s_waitcnt vmcnt(12)
    s_bitcmp1_b32 s48, 6
    s_cbranch_scc1 L_both0
    ds_read_b128 v[104:107], v12 offset:0
    ds_read_b128 v[108:111], v13 offset:0
    ds_read_b128 v[112:115], v14 offset:0
    ds_read_b128 v[116:119], v15 offset:0
    s_bitcmp1_b32 s48, 5
    s_cbranch_scc1 L_sh0
    s_bitcmp1_b32 s48, 7
    s_cbranch_scc1 L_pre0
L_priv0:
    s_waitcnt lgkmcnt(3)
    v_mfma_f32_16x16x32_bf16 v[44:47], v[104:107], v[56:59], 0
    s_waitcnt lgkmcnt(2)
    v_mfma_f32_16x16x32_bf16 v[44:47], v[108:111], v[60:63], v[44:47]
    s_waitcnt lgkmcnt(1)
    v_mfma_f32_16x16x32_bf16 v[44:47], v[112:115], v[64:67], v[44:47]
    s_waitcnt lgkmcnt(0)
    v_mfma_f32_16x16x32_bf16 v[44:47], v[116:119], v[68:71], v[44:47]
    s_waitcnt lgkmcnt(0)
    v_readfirstlane_b32 s51, v22
    v_readfirstlane_b32 s50, v23
    s_cmp_eq_u32 s51, 0
    s_cbranch_scc1 L_retry0a
L_got0a:
    s_cmp_eq_u32 s51, 1051712
    s_cbranch_scc1 L_end0a
    s_add_u32 s52, s52, 1
    v_add_u32 v21, 32, v21
    v_mov_b32 v22, s52
    ds_write_b32 v24, v22
L_issue0a:
    s_bitcmp1_b32 s51, 20
    s_cbranch_scc1 L_fk0
    s_add_u32 m0, s57, 0
    s_nop 0
    s_waitcnt vmcnt(4)
    buffer_load_dwordx4 v4, s[32:35], s50 offen offset:0 nt lds
    buffer_load_dwordx4 v5, s[32:35], s50 offen offset:1024 nt lds
    s_waitcnt vmcnt(4)
    buffer_load_dwordx4 v6, s[32:35], s50 offen offset:2048 nt lds
    buffer_load_dwordx4 v7, s[32:35], s50 offen offset:3072 nt lds
L_fkr0:
    s_and_b32 s60, s48, 31
    s_cmp_eq_u32 s60, 16
    s_cbranch_scc0 L_mask0
L_nomask0:
    v_max3_f32 v28, v44, v45, v46
    v_max_f32 v28, v28, v47
    v_mov_b32 v29, v28
    s_nop 1
    v_permlane32_swap_b32 v28, v29
    v_max_f32 v28, v28, v29
    v_mov_b32 v29, v28
    s_nop 1
    v_permlane16_swap_b32 v28, v29
    v_max_f32 v28, v28, v29
    v_mul_f32 v28, s53, v28
    v_max_f32 v32, v34, v28
    v_sub_f32 v33, v34, v32
    v_fma_f32 v44, v44, s53, -v32
    v_fma_f32 v45, v45, s53, -v32
    v_fma_f32 v46, v46, s53, -v32
    v_fma_f32 v47, v47, s53, -v32
    v_exp_f32 v33, v33
    v_exp_f32 v44, v44
    v_exp_f32 v45, v45
    v_exp_f32 v46, v46
    v_exp_f32 v47, v47
    v_mov_b32 v34, v32
    v_mul_f32_dpp v40, v33, v40 quad_perm:[0,0,0,0] row_mask:0xf bank_mask:0xf
    v_mul_f32_dpp v41, v33, v41 quad_perm:[1,1,1,1] row_mask:0xf bank_mask:0xf
    v_mul_f32_dpp v42, v33, v42 quad_perm:[0,0,0,0] row_mask:0xf bank_mask:0xf
    v_mul_f32_dpp v43, v33, v43 quad_perm:[1,1,1,1] row_mask:0xf bank_mask:0xf
    v_cvt_pk_bf16_f32 v28, v44, v44
    v_cvt_pk_bf16_f32 v29, v45, v45
    v_cvt_pk_bf16_f32 v30, v46, v46
    v_cvt_pk_bf16_f32 v31, v47, v47
    v_and_b32 v120, v28, v16
    v_and_b32 v121, v28, v17
    v_and_b32 v122, v28, v18
    v_and_b32 v123, v28, v19
    v_and_b32 v124, v29, v16
    v_and_b32 v125, v29, v17
    v_and_b32 v126, v29, v18
    v_and_b32 v127, v29, v19
    v_and_b32 v128, v30, v16
    v_and_b32 v129, v30, v17
    v_and_b32 v130, v30, v18
    v_and_b32 v131, v30, v19
    v_and_b32 v132, v31, v16
    v_and_b32 v133, v31, v17
    v_and_b32 v134, v31, v18
    v_and_b32 v135, v31, v19
    v_fma_f32 v35, v35, v33, v44
    v_add_f32 v28, v45, v46
    v_add_f32 v28, v28, v47
    v_add_f32 v35, v35, v28
    s_waitcnt vmcnt(15)
    v_mfma_f32_16x16x32_bf16 v[40:43], v[120:123], v[136:139], v[40:43]
    s_waitcnt vmcnt(14)
    v_mfma_f32_16x16x32_bf16 v[40:43], v[124:127], v[140:143], v[40:43]
    s_waitcnt vmcnt(13)
    v_mfma_f32_16x16x32_bf16 v[40:43], v[128:131], v[144:147], v[40:43]
    s_waitcnt vmcnt(12)
    v_mfma_f32_16x16x32_bf16 v[40:43], v[132:135], v[148:151], v[40:43]
    s_bitcmp1_b32 s48, 10
    s_cbranch_scc1 L_post0
    s_bitcmp1_b32 s51, 20
    s_cbranch_scc1 L_fv0
    s_waitcnt vmcnt(4)
    buffer_load_dwordx4 v[136:139], v8, s[36:39], s50 offen nt
    buffer_load_dwordx4 v[140:143], v9, s[36:39], s50 offen nt
    s_waitcnt vmcnt(4)
    buffer_load_dwordx4 v[144:147], v10, s[36:39], s50 offen nt
    buffer_load_dwordx4 v[148:151], v11, s[36:39], s50 offen nt
L_post0:
    s_and_b32 s60, s48, 1792
    s_mov_b32 s61, s48
    s_mov_b32 s48, s51
    s_cbranch_scc1 L_flags
L_it1:
    ds_read_b32 v22, v21 offset:16
    ds_read_b32 v23, v21
    s_mov_b32 s58, 1
    s_waitcnt vmcnt(12)
    s_bitcmp1_b32 s49, 6
    s_cbranch_scc1 L_both1
    ds_read_b128 v[104:107], v12 offset:4096
    ds_read_b128 v[108:111], v13 offset:4096
    ds_read_b128 v[112:115], v14 offset:4096
    ds_read_b128 v[116:119], v15 offset:4096
    s_bitcmp1_b32 s49, 5
    s_cbranch_scc1 L_sh1
    s_bitcmp1_b32 s49, 7
    s_cbranch_scc1 L_pre1
L_priv1:
    s_waitcnt lgkmcnt(3)
    v_mfma_f32_16x16x32_bf16 v[44:47], v[104:107], v[56:59], 0
    s_waitcnt lgkmcnt(2)
    v_mfma_f32_16x16x32_bf16 v[44:47], v[108:111], v[60:63], v[44:47]
    s_waitcnt lgkmcnt(1)
    v_mfma_f32_16x16x32_bf16 v[44:47], v[112:115], v[64:67], v[44:47]
    s_waitcnt lgkmcnt(0)
    v_mfma_f32_16x16x32_bf16 v[44:47], v[116:119], v[68:71], v[44:47]
    s_waitcnt lgkmcnt(0)
    v_readfirstlane_b32 s51, v22
    v_readfirstlane_b32 s50, v23
    s_cmp_eq_u32 s51, 0
    s_cbranch_scc1 L_retry1a
L_got1a:
    s_cmp_eq_u32 s51, 1051712
    s_cbranch_scc1 L_end1a
    s_add_u32 s52, s52, 1
    v_add_u32 v21, 32, v21
    v_mov_b32 v22, s52
    ds_write_b32 v24, v22
L_issue1a:
    s_bitcmp1_b32 s51, 20
    s_cbranch_scc1 L_fk1
    s_add_u32 m0, s57, 4096
    s_nop 0
    s_waitcnt vmcnt(4)
    buffer_load_dwordx4 v4, s[32:35], s50 offen offset:0 nt lds
    buffer_load_dwordx4 v5, s[32:35], s50 offen offset:1024 nt lds
    s_waitcnt vmcnt(4)
    buffer_load_dwordx4 v6, s[32:35], s50 offen offset:2048 nt lds
    buffer_load_dwordx4 v7, s[32:35], s50 offen offset:3072 nt lds
L_fkr1:
    s_and_b32 s60, s49, 31
    s_cmp_eq_u32 s60, 16
    s_cbranch_scc0 L_mask1
L_nomask1:
    v_max3_f32 v28, v44, v45, v46
    v_max_f32 v28, v28, v47
    v_mov_b32 v29, v28
    s_nop 1
    v_permlane32_swap_b32 v28, v29
    v_max_f32 v28, v28, v29
    v_mov_b32 v29, v28
    s_nop 1
    v_permlane16_swap_b32 v28, v29
    v_max_f32 v28, v28, v29
    v_mul_f32 v28, s53, v28
    v_max_f32 v32, v34, v28
    v_sub_f32 v33, v34, v32
    v_fma_f32 v44, v44, s53, -v32
    v_fma_f32 v45, v45, s53, -v32
    v_fma_f32 v46, v46, s53, -v32
    v_fma_f32 v47, v47, s53, -v32
    v_exp_f32 v33, v33
    v_exp_f32 v44, v44
    v_exp_f32 v45, v45
    v_exp_f32 v46, v46
    v_exp_f32 v47, v47
    v_mov_b32 v34, v32
    v_mul_f32_dpp v40, v33, v40 quad_perm:[0,0,0,0] row_mask:0xf bank_mask:0xf
    v_mul_f32_dpp v41, v33, v41 quad_perm:[1,1,1,1] row_mask:0xf bank_mask:0xf
    v_mul_f32_dpp v42, v33, v42 quad_perm:[0,0,0,0] row_mask:0xf bank_mask:0xf
    v_mul_f32_dpp v43, v33, v43 quad_perm:[1,1,1,1] row_mask:0xf bank_mask:0xf
    v_cvt_pk_bf16_f32 v28, v44, v44
    v_cvt_pk_bf16_f32 v29, v45, v45
    v_cvt_pk_bf16_f32 v30, v46, v46
    v_cvt_pk_bf16_f32 v31, v47, v47
    v_and_b32 v120, v28, v16
    v_and_b32 v121, v28, v17
    v_and_b32 v122, v28, v18
    v_and_b32 v123, v28, v19
    v_and_b32 v124, v29, v16
    v_and_b32 v125, v29, v17
    v_and_b32 v126, v29, v18
    v_and_b32 v127, v29, v19
    v_and_b32 v128, v30, v16
    v_and_b32 v129, v30, v17
    v_and_b32 v130, v30, v18
    v_and_b32 v131, v30, v19
    v_and_b32 v132, v31, v16
    v_and_b32 v133, v31, v17
    v_and_b32 v134, v31, v18
    v_and_b32 v135, v31, v19
    v_fma_f32 v35, v35, v33, v44
    v_add_f32 v28, v45, v46
    v_add_f32 v28, v28, v47
    v_add_f32 v35, v35, v28
    s_waitcnt vmcnt(15)
    v_mfma_f32_16x16x32_bf16 v[40:43], v[120:123], v[152:155], v[40:43]
    s_waitcnt vmcnt(14)
    v_mfma_f32_16x16x32_bf16 v[40:43], v[124:127], v[156:159], v[40:43]
    s_waitcnt vmcnt(13)
    v_mfma_f32_16x16x32_bf16 v[40:43], v[128:131], v[160:163], v[40:43]
    s_waitcnt vmcnt(12)
    v_mfma_f32_16x16x32_bf16 v[40:43], v[132:135], v[164:167], v[40:43]
    s_bitcmp1_b32 s49, 10
    s_cbranch_scc1 L_post1
    s_bitcmp1_b32 s51, 20
    s_cbranch_scc1 L_fv1
    s_waitcnt vmcnt(4)
    buffer_load_dwordx4 v[152:155], v8, s[36:39], s50 offen nt
    buffer_load_dwordx4 v[156:159], v9, s[36:39], s50 offen nt
    s_waitcnt vmcnt(4)
    buffer_load_dwordx4 v[160:163], v10, s[36:39], s50 offen nt
    buffer_load_dwordx4 v[164:167], v11, s[36:39], s50 offen nt
L_post1:
    s_and_b32 s60, s49, 1792
    s_mov_b32 s61, s49
    s_mov_b32 s49, s51
    s_cbranch_scc1 L_flags
    s_branch L_it0
L_both0:
    s_waitcnt lgkmcnt(0)
    v_readfirstlane_b32 s51, v22
    v_readfirstlane_b32 s50, v23
    s_cmp_eq_u32 s51, 0
    s_cbranch_scc1 L_retry0b
L_got0b:
    s_cmp_eq_u32 s51, 1051712
    s_cbranch_scc1 L_end0b
    s_add_u32 s52, s52, 1
    v_add_u32 v21, 32, v21
    v_mov_b32 v22, s52
    ds_write_b32 v24, v22
L_issue0b:
    s_add_u32 m0, s57, 0
    s_nop 0
    buffer_load_dwordx4 v4, s[32:35], s50 offen offset:0 nt lds
    buffer_load_dwordx4 v5, s[32:35], s50 offen offset:1024 nt lds
    buffer_load_dwordx4 v6, s[32:35], s50 offen offset:2048 nt lds
    buffer_load_dwordx4 v7, s[32:35], s50 offen offset:3072 nt lds
    buffer_load_dwordx4 v[136:139], v8, s[36:39], s50 offen nt
    buffer_load_dwordx4 v[140:143], v9, s[36:39], s50 offen nt
    buffer_load_dwordx4 v[144:147], v10, s[36:39], s50 offen nt
    buffer_load_dwordx4 v[148:151], v11, s[36:39], s50 offen nt
    s_mov_b32 s72, 0
    s_bitcmp1_b32 s48, 5
    s_cbranch_scc1 L_shc2
    s_branch L_post0
L_fk0:
    s_add_u32 m0, s57, 0
    s_nop 0
    buffer_load_dwordx4 v4, s[32:35], s50 offen offset:0 nt lds
    buffer_load_dwordx4 v5, s[32:35], s50 offen offset:1024 nt lds
    buffer_load_dwordx4 v6, s[32:35], s50 offen offset:2048 nt lds
    buffer_load_dwordx4 v7, s[32:35], s50 offen offset:3072 nt lds
    s_branch L_fkr0
L_fv0:
    buffer_load_dwordx4 v[136:139], v8, s[36:39], s50 offen nt
    buffer_load_dwordx4 v[140:143], v9, s[36:39], s50 offen nt
    buffer_load_dwordx4 v[144:147], v10, s[36:39], s50 offen nt
    buffer_load_dwordx4 v[148:151], v11, s[36:39], s50 offen nt
    s_branch L_post0
L_end0a:
    s_mov_b32 s51, 1050688
    s_cmp_eq_u32 s49, 1050688
    s_cbranch_scc1 L_endme0a
    s_bitset1_b32 s49, 10
    s_branch L_issue0a
L_endme0a:
    s_bitset1_b32 s48, 10
    s_branch L_issue0a
L_retry0a:
    ds_read_b32 v22, v21 offset:16
    ds_read_b32 v23, v21
    s_waitcnt lgkmcnt(0)
    v_readfirstlane_b32 s51, v22
    v_readfirstlane_b32 s50, v23
    s_cmp_lg_u32 s51, 0
    s_cbranch_scc1 L_got0a
    s_nop 2
    s_mov_b32 s50, 2147483648
    s_mov_b32 s51, 1050688
    s_branch L_issue0a
L_end0b:
    s_mov_b32 s51, 1050688
    s_cmp_eq_u32 s49, 1050688
    s_cbranch_scc1 L_endme0b
    s_bitset1_b32 s49, 10
    s_branch L_issue0b
L_endme0b:
    s_bitset1_b32 s48, 10
    s_branch L_issue0b
L_retry0b:
    ds_read_b32 v22, v21 offset:16
    ds_read_b32 v23, v21
    s_waitcnt lgkmcnt(0)
    v_readfirstlane_b32 s51, v22
    v_readfirstlane_b32 s50, v23
    s_cmp_lg_u32 s51, 0
    s_cbranch_scc1 L_got0b
    s_nop 2
    s_mov_b32 s50, 2147483648
    s_mov_b32 s51, 1050688
    s_cmp_lg_u32 s49, 1050688
    s_cbranch_scc1 L_issue0b
    s_cmp_lg_u32 s48, 1050688
    s_cbranch_scc1 L_issue0b
    s_sleep 2
    s_sub_u32 s9, s9, 1
    s_cbranch_scc1 L_exit
    s_branch L_issue0b
L_mask0:
    s_cmp_eq_u32 s60, 0
    s_cselect_b32 s61, 0, s56
    v_mov_b32 v29, s61
    v_add_u32 v28, 0, v20
    v_cmp_gt_u32 vcc, s60, v28
    s_nop 1
    v_cndmask_b32 v44, v29, v44, vcc
    v_add_u32 v28, 1, v20
    v_cmp_gt_u32 vcc, s60, v28
    s_nop 1
    v_cndmask_b32 v45, v29, v45, vcc
    v_add_u32 v28, 2, v20
    v_cmp_gt_u32 vcc, s60, v28
    s_nop 1
    v_cndmask_b32 v46, v29, v46, vcc
    v_add_u32 v28, 3, v20
    v_cmp_gt_u32 vcc, s60, v28
    s_nop 1
    v_cndmask_b32 v47, v29, v47, vcc
    s_branch L_nomask0
L_pre0:
    s_bitcmp1_b32 s48, 16
    s_cbranch_scc0 L_prens0
    v_mov_b32 v234, v34
    v_mov_b32 v235, v35
    v_mov_b32 v236, v40
    v_mov_b32 v237, v41
    v_mov_b32 v238, v42
    v_mov_b32 v239, v43
L_prens0:
    s_bfe_u32 s60, s52, 0x80008
    s_add_u32 s60, s60, 1
    v_mov_b32 v28, 62484
L_preq0:
    ds_read_b32 v29, v28
    s_waitcnt lgkmcnt(0)
    v_cmp_lt_u32 vcc, s60, v29
    s_cbranch_vccnz L_preok0
    s_sleep 1
    s_sub_u32 s9, s9, 1
    s_cbranch_scc1 L_exit
    s_branch L_preq0
L_preok0:
    s_bfe_u32 s60, s52, 0x30008
    s_lshl_b32 s60, s60, 9
    v_add_u32 v28, s60, v25
    ds_read_b128 v[56:59], v28 offset:0
    ds_read_b128 v[60:63], v28 offset:64
    ds_read_b128 v[64:67], v28 offset:128
    ds_read_b128 v[68:71], v28 offset:192
    v_mov_b32 v34, 0xff61b1e6
    v_mov_b32 v35, 0
    v_mov_b32 v40, 0
    v_mov_b32 v41, 0
    v_mov_b32 v42, 0
    v_mov_b32 v43, 0
    s_waitcnt lgkmcnt(0)
    s_branch L_priv0
L_sh0:
    s_waitcnt vmcnt(8)
    v_perm_b32 v120, v140, v136, s54
    v_perm_b32 v121, v148, v144, s54
    v_perm_b32 v122, v140, v136, s55
    v_perm_b32 v123, v148, v144, s55
    v_perm_b32 v124, v141, v137, s54
    v_perm_b32 v125, v149, v145, s54
    v_perm_b32 v126, v141, v137, s55
    v_perm_b32 v127, v149, v145, s55
    v_perm_b32 v128, v142, v138, s54
    v_perm_b32 v129, v150, v146, s54
    v_perm_b32 v130, v142, v138, s55
    v_perm_b32 v131, v150, v146, s55
    v_perm_b32 v132, v143, v139, s54
    v_perm_b32 v133, v151, v147, s54
    v_perm_b32 v134, v143, v139, s55
    v_perm_b32 v135, v151, v147, s55
    s_bitcmp1_b32 s48, 7
    s_branch L_shc
L_both1:
    s_waitcnt lgkmcnt(0)
    v_readfirstlane_b32 s51, v22
    v_readfirstlane_b32 s50, v23
    s_cmp_eq_u32 s51, 0
    s_cbranch_scc1 L_retry1b
L_got1b:
    s_cmp_eq_u32 s51, 1051712
    s_cbranch_scc1 L_end1b
    s_add_u32 s52, s52, 1
    v_add_u32 v21, 32, v21
    v_mov_b32 v22, s52
    ds_write_b32 v24, v22
L_issue1b:
    s_add_u32 m0, s57, 4096
    s_nop 0
    buffer_load_dwordx4 v4, s[32:35], s50 offen offset:0 nt lds
    buffer_load_dwordx4 v5, s[32:35], s50 offen offset:1024 nt lds
    buffer_load_dwordx4 v6, s[32:35], s50 offen offset:2048 nt lds
    buffer_load_dwordx4 v7, s[32:35], s50 offen offset:3072 nt lds
    buffer_load_dwordx4 v[152:155], v8, s[36:39], s50 offen nt
    buffer_load_dwordx4 v[156:159], v9, s[36:39], s50 offen nt
    buffer_load_dwordx4 v[160:163], v10, s[36:39], s50 offen nt
    buffer_load_dwordx4 v[164:167], v11, s[36:39], s50 offen nt
    s_mov_b32 s72, 0
    s_bitcmp1_b32 s49, 5
    s_cbranch_scc1 L_shc2
    s_branch L_post1
L_fk1:
    s_add_u32 m0, s57, 4096
    s_nop 0
    buffer_load_dwordx4 v4, s[32:35], s50 offen offset:0 nt lds
    buffer_load_dwordx4 v5, s[32:35], s50 offen offset:1024 nt lds
    buffer_load_dwordx4 v6, s[32:35], s50 offen offset:2048 nt lds
    buffer_load_dwordx4 v7, s[32:35], s50 offen offset:3072 nt lds
    s_branch L_fkr1
L_fv1:
    buffer_load_dwordx4 v[152:155], v8, s[36:39], s50 offen nt
    buffer_load_dwordx4 v[156:159], v9, s[36:39], s50 offen nt
    buffer_load_dwordx4 v[160:163], v10, s[36:39], s50 offen nt
    buffer_load_dwordx4 v[164:167], v11, s[36:39], s50 offen nt
    s_branch L_post1
L_end1a:
    s_mov_b32 s51, 1050688
    s_cmp_eq_u32 s48, 1050688
    s_cbranch_scc1 L_endme1a
    s_bitset1_b32 s48, 10
    s_branch L_issue1a
L_endme1a:
    s_bitset1_b32 s49, 10
    s_branch L_issue1a
L_retry1a:
    ds_read_b32 v22, v21 offset:16
    ds_read_b32 v23, v21
    s_waitcnt lgkmcnt(0)
    v_readfirstlane_b32 s51, v22
    v_readfirstlane_b32 s50, v23
    s_cmp_lg_u32 s51, 0
    s_cbranch_scc1 L_got1a
    s_nop 2
    s_mov_b32 s50, 2147483648
    s_mov_b32 s51, 1050688
    s_branch L_issue1a
L_end1b:
    s_mov_b32 s51, 1050688
    s_cmp_eq_u32 s48, 1050688
    s_cbranch_scc1 L_endme1b
    s_bitset1_b32 s48, 10
    s_branch L_issue1b
L_endme1b:
    s_bitset1_b32 s49, 10
    s_branch L_issue1b
L_retry1b:
    ds_read_b32 v22, v21 offset:16
    ds_read_b32 v23, v21
    s_waitcnt lgkmcnt(0)
    v_readfirstlane_b32 s51, v22
    v_readfirstlane_b32 s50, v23
    s_cmp_lg_u32 s51, 0
    s_cbranch_scc1 L_got1b
    s_nop 2
    s_mov_b32 s50, 2147483648
    s_mov_b32 s51, 1050688
    s_cmp_lg_u32 s48, 1050688
    s_cbranch_scc1 L_issue1b
    s_cmp_lg_u32 s49, 1050688
    s_cbranch_scc1 L_issue1b
    s_sleep 2
    s_sub_u32 s9, s9, 1
    s_cbranch_scc1 L_exit
    s_branch L_issue1b
L_mask1:
    s_cmp_eq_u32 s60, 0
    s_cselect_b32 s61, 0, s56
    v_mov_b32 v29, s61
    v_add_u32 v28, 0, v20
    v_cmp_gt_u32 vcc, s60, v28
    s_nop 1
    v_cndmask_b32 v44, v29, v44, vcc
    v_add_u32 v28, 1, v20
    v_cmp_gt_u32 vcc, s60, v28
    s_nop 1
    v_cndmask_b32 v45, v29, v45, vcc
    v_add_u32 v28, 2, v20
    v_cmp_gt_u32 vcc, s60, v28
    s_nop 1
    v_cndmask_b32 v46, v29, v46, vcc
    v_add_u32 v28, 3, v20
    v_cmp_gt_u32 vcc, s60, v28
    s_nop 1
    v_cndmask_b32 v47, v29, v47, vcc
    s_branch L_nomask1
L_pre1:
    s_bitcmp1_b32 s49, 16
    s_cbranch_scc0 L_prens1
    v_mov_b32 v234, v34
    v_mov_b32 v235, v35
    v_mov_b32 v236, v40
    v_mov_b32 v237, v41
    v_mov_b32 v238, v42
    v_mov_b32 v239, v43
L_prens1:
    s_bfe_u32 s60, s52, 0x80008
    s_add_u32 s60, s60, 1
    v_mov_b32 v28, 62484
L_preq1:
    ds_read_b32 v29, v28
    s_waitcnt lgkmcnt(0)
    v_cmp_lt_u32 vcc, s60, v29
    s_cbranch_vccnz L_preok1
    s_sleep 1
    s_sub_u32 s9, s9, 1
    s_cbranch_scc1 L_exit
    s_branch L_preq1
L_preok1:
    s_bfe_u32 s60, s52, 0x30008
    s_lshl_b32 s60, s60, 9
    v_add_u32 v28, s60, v25
    ds_read_b128 v[56:59], v28 offset:0
    ds_read_b128 v[60:63], v28 offset:64
    ds_read_b128 v[64:67], v28 offset:128
    ds_read_b128 v[68:71], v28 offset:192
    v_mov_b32 v34, 0xff61b1e6
    v_mov_b32 v35, 0
    v_mov_b32 v40, 0
    v_mov_b32 v41, 0
    v_mov_b32 v42, 0
    v_mov_b32 v43, 0
    s_waitcnt lgkmcnt(0)
    s_branch L_priv1
L_sh1:
    s_waitcnt vmcnt(8)
    v_perm_b32 v120, v156, v152, s54
    v_perm_b32 v121, v164, v160, s54
    v_perm_b32 v122, v156, v152, s55
    v_perm_b32 v123, v164, v160, s55
    v_perm_b32 v124, v157, v153, s54
    v_perm_b32 v125, v165, v161, s54
    v_perm_b32 v126, v157, v153, s55
    v_perm_b32 v127, v165, v161, s55
    v_perm_b32 v128, v158, v154, s54
    v_perm_b32 v129, v166, v162, s54
    v_perm_b32 v130, v158, v154, s55
    v_perm_b32 v131, v166, v162, s55
    v_perm_b32 v132, v159, v155, s54
    v_perm_b32 v133, v167, v163, s54
    v_perm_b32 v134, v159, v155, s55
    v_perm_b32 v135, v167, v163, s55
    s_bitcmp1_b32 s49, 7
L_shc:
    s_cbranch_scc0 L_shq
    v_mov_b32 v28, 62484
L_shw:
    ds_read_b32 v29, v28
    s_waitcnt lgkmcnt(0)
    v_cmp_lt_u32 vcc, 0, v29
    s_cbranch_vccnz L_shwok
    s_sleep 1
    s_sub_u32 s9, s9, 1
    s_cbranch_scc1 L_exit
    s_branch L_shw
L_shwok:
    v_lshrrev_b32 v28, 1, v2
    v_lshl_add_u32 v28, v28, 9, v25
    v_add_u32 v28, 96768, v28
    ds_read_b128 v[72:75], v28 offset:0
    ds_read_b128 v[76:79], v28 offset:64
    ds_read_b128 v[80:83], v28 offset:128
    ds_read_b128 v[84:87], v28 offset:192
    ds_read_b128 v[88:91], v28 offset:4096
    ds_read_b128 v[92:95], v28 offset:4160
    ds_read_b128 v[96:99], v28 offset:4224
    ds_read_b128 v[100:103], v28 offset:4288
    v_mov_b32 v168, 0
    v_mov_b32 v169, 0
    v_mov_b32 v170, 0
    v_mov_b32 v171, 0
    v_mov_b32 v172, 0
    v_mov_b32 v173, 0
    v_mov_b32 v174, 0
    v_mov_b32 v175, 0
    v_mov_b32 v176, 0
    v_mov_b32 v177, 0
    v_mov_b32 v178, 0
    v_mov_b32 v179, 0
    v_mov_b32 v180, 0
    v_mov_b32 v181, 0
    v_mov_b32 v182, 0
    v_mov_b32 v183, 0
    v_mov_b32 v184, 0
    v_mov_b32 v185, 0
    v_mov_b32 v186, 0
    v_mov_b32 v187, 0
    v_mov_b32 v188, 0
    v_mov_b32 v189, 0
    v_mov_b32 v190, 0
    v_mov_b32 v191, 0
    v_mov_b32 v192, 0
    v_mov_b32 v193, 0
    v_mov_b32 v194, 0
    v_mov_b32 v195, 0
    v_mov_b32 v196, 0
    v_mov_b32 v197, 0
    v_mov_b32 v198, 0
    v_mov_b32 v199, 0
    v_mov_b32 v200, 0
    v_mov_b32 v201, 0
    v_mov_b32 v202, 0
    v_mov_b32 v203, 0
    v_mov_b32 v204, 0
    v_mov_b32 v205, 0
    v_mov_b32 v206, 0
    v_mov_b32 v207, 0
    v_mov_b32 v208, 0
    v_mov_b32 v209, 0
    v_mov_b32 v210, 0
    v_mov_b32 v211, 0
    v_mov_b32 v212, 0
    v_mov_b32 v213, 0
    v_mov_b32 v214, 0
    v_mov_b32 v215, 0
    v_mov_b32 v216, 0
    v_mov_b32 v217, 0
    v_mov_b32 v218, 0
    v_mov_b32 v219, 0
    v_mov_b32 v220, 0
    v_mov_b32 v221, 0
    v_mov_b32 v222, 0
    v_mov_b32 v223, 0
    v_mov_b32 v224, 0
    v_mov_b32 v225, 0
    v_mov_b32 v226, 0
    v_mov_b32 v227, 0
    v_mov_b32 v228, 0
    v_mov_b32 v229, 0
    v_mov_b32 v230, 0
    v_mov_b32 v231, 0
    s_waitcnt lgkmcnt(0)
L_shq:
    s_waitcnt lgkmcnt(3)
    v_mfma_f32_16x16x32_bf16 v[44:47], v[104:107], v[72:75], 0
    v_mfma_f32_16x16x32_bf16 v[48:51], v[104:107], v[88:91], 0
    s_waitcnt lgkmcnt(2)
    v_mfma_f32_16x16x32_bf16 v[44:47], v[108:111], v[76:79], v[44:47]
    v_mfma_f32_16x16x32_bf16 v[48:51], v[108:111], v[92:95], v[48:51]
    s_waitcnt lgkmcnt(1)
    v_mfma_f32_16x16x32_bf16 v[44:47], v[112:115], v[80:83], v[44:47]
    v_mfma_f32_16x16x32_bf16 v[48:51], v[112:115], v[96:99], v[48:51]
    s_waitcnt lgkmcnt(0)
    v_mfma_f32_16x16x32_bf16 v[44:47], v[116:119], v[84:87], v[44:47]
    v_mfma_f32_16x16x32_bf16 v[48:51], v[116:119], v[100:103], v[48:51]
    s_cmp_eq_u32 s58, 0
    s_cbranch_scc1 L_both0
    s_branch L_both1
L_shc2:
    v_max3_f32 v28, v44, v45, v46
    v_max3_f32 v30, v48, v49, v50
    v_max_f32 v28, v28, v47
    v_max_f32 v30, v30, v51
    v_mov_b32 v29, v28
    v_mov_b32 v31, v30
    s_nop 0
    v_permlane32_swap_b32 v28, v29
    v_permlane32_swap_b32 v30, v31
    v_max_f32 v28, v28, v29
    v_max_f32 v30, v30, v31
    v_mov_b32 v29, v28
    v_mov_b32 v31, v30
    s_nop 0
    v_permlane16_swap_b32 v28, v29
    v_permlane16_swap_b32 v30, v31
    v_max_f32 v28, v28, v29
    v_max_f32 v30, v30, v31
    v_mul_f32 v28, s53, v28
    v_mul_f32 v30, s53, v30
    v_max_f32 v32, v36, v28
    v_max_f32 v232, v38, v30
    v_sub_f32 v33, v36, v32
    v_sub_f32 v233, v38, v232
    v_min_f32 v28, v33, v233
    v_cmp_gt_f32 vcc, 0, v28
    v_fma_f32 v44, v44, s53, -v32
    v_fma_f32 v48, v48, s53, -v232
    v_fma_f32 v45, v45, s53, -v32
    v_fma_f32 v49, v49, s53, -v232
    v_fma_f32 v46, v46, s53, -v32
    v_fma_f32 v50, v50, s53, -v232
    v_fma_f32 v47, v47, s53, -v32
    v_fma_f32 v51, v51, s53, -v232
    v_exp_f32 v33, v33
    v_exp_f32 v233, v233
    v_exp_f32 v44, v44
    v_exp_f32 v45, v45
    v_exp_f32 v46, v46
    v_exp_f32 v47, v47
    v_exp_f32 v48, v48
    v_exp_f32 v49, v49
    v_exp_f32 v50, v50
    v_exp_f32 v51, v51
    v_mov_b32 v36, v32
    v_mov_b32 v38, v232
    s_cbranch_vccz L_shnr
    v_mul_f32 v168, v33, v168
    v_mul_f32 v169, v33, v169
    v_mul_f32 v170, v33, v170
    v_mul_f32 v171, v33, v171
    v_mul_f32 v172, v33, v172
    v_mul_f32 v173, v33, v173
    v_mul_f32 v174, v33, v174
    v_mul_f32 v175, v33, v175
    v_mul_f32 v176, v33, v176
    v_mul_f32 v177, v33, v177
    v_mul_f32 v178, v33, v178
    v_mul_f32 v179, v33, v179
    v_mul_f32 v180, v33, v180
    v_mul_f32 v181, v33, v181
    v_mul_f32 v182, v33, v182
    v_mul_f32 v183, v33, v183
    v_mul_f32 v184, v33, v184
    v_mul_f32 v185, v33, v185
    v_mul_f32 v186, v33, v186
    v_mul_f32 v187, v33, v187
    v_mul_f32 v188, v33, v188
    v_mul_f32 v189, v33, v189
    v_mul_f32 v190, v33, v190
    v_mul_f32 v191, v33, v191
    v_mul_f32 v192, v33, v192
    v_mul_f32 v193, v33, v193
    v_mul_f32 v194, v33, v194
    v_mul_f32 v195, v33, v195
    v_mul_f32 v196, v33, v196
    v_mul_f32 v197, v33, v197
    v_mul_f32 v198, v33, v198
    v_mul_f32 v199, v33, v199
    v_mul_f32 v200, v233, v200
    v_mul_f32 v201, v233, v201
    v_mul_f32 v202, v233, v202
    v_mul_f32 v203, v233, v203
    v_mul_f32 v204, v233, v204
    v_mul_f32 v205, v233, v205
    v_mul_f32 v206, v233, v206
    v_mul_f32 v207, v233, v207
    v_mul_f32 v208, v233, v208
    v_mul_f32 v209, v233, v209
    v_mul_f32 v210, v233, v210
    v_mul_f32 v211, v233, v211
    v_mul_f32 v212, v233, v212
    v_mul_f32 v213, v233, v213
    v_mul_f32 v214, v233, v214
    v_mul_f32 v215, v233, v215
    v_mul_f32 v216, v233, v216
    v_mul_f32 v217, v233, v217
    v_mul_f32 v218, v233, v218
    v_mul_f32 v219, v233, v219
    v_mul_f32 v220, v233, v220
    v_mul_f32 v221, v233, v221
    v_mul_f32 v222, v233, v222
    v_mul_f32 v223, v233, v223
    v_mul_f32 v224, v233, v224
    v_mul_f32 v225, v233, v225
    v_mul_f32 v226, v233, v226
    v_mul_f32 v227, v233, v227
    v_mul_f32 v228, v233, v228
    v_mul_f32 v229, v233, v229
    v_mul_f32 v230, v233, v230
    v_mul_f32 v231, v233, v231
L_shnr:
    v_cvt_pk_bf16_f32 v52, v44, v45
    v_cvt_pk_bf16_f32 v53, v46, v47
    v_cvt_pk_bf16_f32 v54, v48, v49
    v_cvt_pk_bf16_f32 v55, v50, v51
    v_fma_f32 v37, v37, v33, v44
    v_fma_f32 v39, v39, v233, v48
    v_mfma_f32_16x16x16_bf16 v[168:171], v[120:121], v[52:53], v[168:171]
    v_add_f32 v28, v45, v46
    v_mfma_f32_16x16x16_bf16 v[172:175], v[122:123], v[52:53], v[172:175]
    v_add_f32 v30, v49, v50
    v_mfma_f32_16x16x16_bf16 v[176:179], v[124:125], v[52:53], v[176:179]
    v_add_f32 v28, v28, v47
    v_mfma_f32_16x16x16_bf16 v[180:183], v[126:127], v[52:53], v[180:183]
    v_add_f32 v30, v30, v51
    v_mfma_f32_16x16x16_bf16 v[184:187], v[128:129], v[52:53], v[184:187]
    v_add_f32 v37, v37, v28
    v_mfma_f32_16x16x16_bf16 v[188:191], v[130:131], v[52:53], v[188:191]
    v_add_f32 v39, v39, v30
    v_mfma_f32_16x16x16_bf16 v[192:195], v[132:133], v[52:53], v[192:195]
    v_mfma_f32_16x16x16_bf16 v[196:199], v[134:135], v[52:53], v[196:199]
    v_mfma_f32_16x16x16_bf16 v[200:203], v[120:121], v[54:55], v[200:203]
    v_mfma_f32_16x16x16_bf16 v[204:207], v[122:123], v[54:55], v[204:207]
    v_mfma_f32_16x16x16_bf16 v[208:211], v[124:125], v[54:55], v[208:211]
    v_mfma_f32_16x16x16_bf16 v[212:215], v[126:127], v[54:55], v[212:215]
    v_mfma_f32_16x16x16_bf16 v[216:219], v[128:129], v[54:55], v[216:219]
    v_mfma_f32_16x16x16_bf16 v[220:223], v[130:131], v[54:55], v[220:223]
    v_mfma_f32_16x16x16_bf16 v[224:227], v[132:133], v[54:55], v[224:227]
    v_mfma_f32_16x16x16_bf16 v[228:231], v[134:135], v[54:55], v[228:231]
    s_cmp_eq_u32 s58, 0
    s_cbranch_scc1 L_post0
    s_branch L_post1
L_flags:
    s_bitcmp1_b32 s61, 9
    s_cbranch_scc0 L_fl_priv
    v_mov_b32 v28, v37
    s_nop 1
    v_permlane32_swap_b32 v37, v28
    v_add_f32 v37, v37, v28
    v_mov_b32 v28, v37
    s_nop 1
    v_permlane16_swap_b32 v37, v28
    v_add_f32 v37, v37, v28
    v_mov_b32 v28, v39
    s_nop 1
    v_permlane32_swap_b32 v39, v28
    v_add_f32 v39, v39, v28
    v_mov_b32 v28, v39
    s_nop 1
    v_permlane16_swap_b32 v39, v28
    v_add_f32 v39, v39, v28
    ds_write_b32 v27, v168 offset:0
    ds_write_b32 v27, v169 offset:16
    ds_write_b32 v27, v170 offset:32
    ds_write_b32 v27, v171 offset:48
    ds_write_b32 v27, v172 offset:8
    ds_write_b32 v27, v173 offset:24
    ds_write_b32 v27, v174 offset:40
    ds_write_b32 v27, v175 offset:56
    ds_write_b32 v27, v176 offset:256
    ds_write_b32 v27, v177 offset:272
    ds_write_b32 v27, v178 offset:288
    ds_write_b32 v27, v179 offset:304
    ds_write_b32 v27, v180 offset:264
    ds_write_b32 v27, v181 offset:280
    ds_write_b32 v27, v182 offset:296
    ds_write_b32 v27, v183 offset:312
    ds_write_b32 v27, v184 offset:512
    ds_write_b32 v27, v185 offset:528
    ds_write_b32 v27, v186 offset:544
    ds_write_b32 v27, v187 offset:560
    ds_write_b32 v27, v188 offset:520
    ds_write_b32 v27, v189 offset:536
    ds_write_b32 v27, v190 offset:552
    ds_write_b32 v27, v191 offset:568
    ds_write_b32 v27, v192 offset:768
    ds_write_b32 v27, v193 offset:784
    ds_write_b32 v27, v194 offset:800
    ds_write_b32 v27, v195 offset:816
    ds_write_b32 v27, v196 offset:776
    ds_write_b32 v27, v197 offset:792
    ds_write_b32 v27, v198 offset:808
    ds_write_b32 v27, v199 offset:824
    ds_write_b32 v27, v200 offset:8320
    ds_write_b32 v27, v201 offset:8336
    ds_write_b32 v27, v202 offset:8352
    ds_write_b32 v27, v203 offset:8368
    ds_write_b32 v27, v204 offset:8328
    ds_write_b32 v27, v205 offset:8344
    ds_write_b32 v27, v206 offset:8360
    ds_write_b32 v27, v207 offset:8376
    ds_write_b32 v27, v208 offset:8576
    ds_write_b32 v27, v209 offset:8592
    ds_write_b32 v27, v210 offset:8608
    ds_write_b32 v27, v211 offset:8624
    ds_write_b32 v27, v212 offset:8584
    ds_write_b32 v27, v213 offset:8600
    ds_write_b32 v27, v214 offset:8616
    ds_write_b32 v27, v215 offset:8632
    ds_write_b32 v27, v216 offset:8832
    ds_write_b32 v27, v217 offset:8848
    ds_write_b32 v27, v218 offset:8864
    ds_write_b32 v27, v219 offset:8880
    ds_write_b32 v27, v220 offset:8840
    ds_write_b32 v27, v221 offset:8856
    ds_write_b32 v27, v222 offset:8872
    ds_write_b32 v27, v223 offset:8888
    ds_write_b32 v27, v224 offset:9088
    ds_write_b32 v27, v225 offset:9104
    ds_write_b32 v27, v226 offset:9120
    ds_write_b32 v27, v227 offset:9136
    ds_write_b32 v27, v228 offset:9096
    ds_write_b32 v27, v229 offset:9112
    ds_write_b32 v27, v230 offset:9128
    ds_write_b32 v27, v231 offset:9144
    v_and_b32 v28, 1, v2
    v_lshl_add_u32 v28, v28, 2, v27
    s_mov_b64 exec, 0xffff
    ds_write_b64 v28, v[36:37] offset:1024
    ds_write_b64 v28, v[38:39] offset:9344
    s_mov_b64 exec, -1
    s_bitset1_b32 s52, 16
    v_mov_b32 v28, s52
    s_waitcnt lgkmcnt(0)
    ds_write_b32 v24, v28
L_fl_priv:
    s_bitcmp1_b32 s61, 8
    s_cbranch_scc0 L_fl_end
    v_mov_b32 v28, v35
    s_nop 1
    v_permlane32_swap_b32 v35, v28
    v_add_f32 v35, v35, v28
    v_mov_b32 v28, v35
    s_nop 1
    v_permlane16_swap_b32 v35, v28
    v_add_f32 v35, v35, v28
    s_bfe_u32 s60, s52, 0x20008
    s_mul_i32 s60, s60, 4160
    v_add_u32 v28, s60, v26
    ds_write_b128 v28, v[40:43]
    v_lshlrev_b32 v29, 3, v1
    v_sub_u32 v28, v28, v29
    s_mov_b64 exec, 3
    ds_write_b64 v28, v[34:35] offset:1024
    s_mov_b64 exec, -1
    s_add_u32 s52, s52, 0x100
    v_mov_b32 v28, s52
    s_waitcnt lgkmcnt(0)
    ds_write_b32 v24, v28
    s_bitcmp1_b32 s61, 17
    s_cbranch_scc0 L_fl_end
    v_add_u32 v29, 4096, v25
    ds_read_b128 v[56:59], v29
    ds_read_b128 v[60:63], v29 offset:64
    ds_read_b128 v[64:67], v29 offset:128
    ds_read_b128 v[68:71], v29 offset:192
    v_mov_b32 v34, v234
    v_mov_b32 v35, v235
    v_mov_b32 v40, v236
    v_mov_b32 v41, v237
    v_mov_b32 v42, v238
    v_mov_b32 v43, v239
L_fl_end:
    s_bitcmp1_b32 s61, 10
    s_cbranch_scc1 L_stream_done
    s_cmp_eq_u32 s58, 0
    s_cbranch_scc1 L_it1
    s_cmp_eq_u32 s58, 1
    s_cbranch_scc1 L_it0
    s_branch L_it0
L_stream_done:
    s_waitcnt lgkmcnt(0)
    s_endpgm
L_sched:
    s_setprio 3
    v_lshlrev_b32 v2, 4, v1
    v_and_b32 v6, 15, v1
    v_lshlrev_b32 v3, 2, v6
    s_mov_b32 s34, 16384
    s_mov_b32 s35, 0x20000
    s_mov_b32 s38, 64
    s_mov_b32 s39, 0x20000
    s_mov_b32 m0, 32768
    s_waitcnt lgkmcnt(0)
    s_mov_b64 s[32:33], s[22:23]
    s_mov_b64 s[36:37], s[24:25]
    buffer_load_dword v7, v3, s[36:39], 0 offen
    s_mov_b32 s48, 0
    buffer_load_dwordx4 v2, s[32:35], s48 offen offset:0 lds
    buffer_load_dwordx4 v2, s[32:35], s48 offen offset:1024 lds
    buffer_load_dwordx4 v2, s[32:35], s48 offen offset:2048 lds
    buffer_load_dwordx4 v2, s[32:35], s48 offen offset:3072 lds
    s_mov_b32 m0, 36864
    s_mov_b32 s48, 4096
    buffer_load_dwordx4 v2, s[32:35], s48 offen offset:0 lds
    buffer_load_dwordx4 v2, s[32:35], s48 offen offset:1024 lds
    buffer_load_dwordx4 v2, s[32:35], s48 offen offset:2048 lds
    buffer_load_dwordx4 v2, s[32:35], s48 offen offset:3072 lds
    s_mov_b32 m0, 40960
    s_mov_b32 s48, 8192
    buffer_load_dwordx4 v2, s[32:35], s48 offen offset:0 lds
    buffer_load_dwordx4 v2, s[32:35], s48 offen offset:1024 lds
    buffer_load_dwordx4 v2, s[32:35], s48 offen offset:2048 lds
    buffer_load_dwordx4 v2, s[32:35], s48 offen offset:3072 lds
    s_mov_b32 m0, 45056
    s_mov_b32 s48, 12288
    buffer_load_dwordx4 v2, s[32:35], s48 offen offset:0 lds
    buffer_load_dwordx4 v2, s[32:35], s48 offen offset:1024 lds
    buffer_load_dwordx4 v2, s[32:35], s48 offen offset:2048 lds
    buffer_load_dwordx4 v2, s[32:35], s48 offen offset:3072 lds
    v_mov_b32 v26, 0
    v_mov_b32 v16, 0
    v_mov_b32 v17, 0
    v_mov_b32 v18, 0
    v_mov_b32 v19, 0
    ds_write_b128 v2, v[16:19] offset:57344
    ds_write_b128 v2, v[16:19] offset:58368
    ds_write_b128 v2, v[16:19] offset:59392
    ds_write_b128 v2, v[16:19] offset:60416
    ds_write_b128 v2, v[16:19] offset:61440
    v_lshlrev_b32 v25, 2, v1
    ds_write_b32 v25, v26 offset:62464
    v_and_b32 v102, 31, v1
    v_lshlrev_b32 v102, 4, v102
    v_lshrrev_b32 v4, 5, v1
    v_lshl_add_u32 v103, v4, 13, v102
    s_mov_b32 s40, s16
    s_mov_b32 s41, s17
    s_mov_b32 s42, 131072
    s_mov_b32 s43, 0x20000
    s_mov_b32 s62, 0
    s_mov_b32 s58, 2
    s_movk_i32 s48, 4096
    s_waitcnt lgkmcnt(0)
    s_barrier
    s_waitcnt vmcnt(16)
    v_med3_i32 v3, v7, 0, s48
    v_add_u32 v7, 63, v3
    v_lshrrev_b32 v7, 6, v7
    v_cmp_eq_u32 vcc, 0, v7
    v_lshrrev_b32 v3, 6, v3
    s_and_b32 s63, vcc_lo, 0xffff
    v_cndmask_b32_e64 v7, v7, 64, vcc
    v_subrev_u32 v4, 4, v7
    v_max_i32 v4, 0, v4
    v_min_u32 v3, v3, v4
    v_mov_b32 v4, v7
    v_lshl_add_u32 v5, v7, 4, v6
    v_mov_b32 v8, 0
    v_min_u32_dpp v3, v3, v3 row_ror:8 row_mask:0xf bank_mask:0xf
    v_add_u32_dpp v4, v4, v4 row_ror:8 row_mask:0xf bank_mask:0xf
    s_nop 0
    v_min_u32_dpp v3, v3, v3 row_ror:4 row_mask:0xf bank_mask:0xf
    v_add_u32_dpp v4, v4, v4 row_ror:4 row_mask:0xf bank_mask:0xf
    s_nop 0
    v_min_u32_dpp v3, v3, v3 row_ror:2 row_mask:0xf bank_mask:0xf
    v_add_u32_dpp v4, v4, v4 row_ror:2 row_mask:0xf bank_mask:0xf
    s_nop 0
    v_min_u32_dpp v3, v3, v3 row_ror:1 row_mask:0xf bank_mask:0xf
    v_add_u32_dpp v4, v4, v4 row_ror:1 row_mask:0xf bank_mask:0xf
    s_nop 0
    v_sub_u32_dpp v9, v5, v5 row_ror:1 row_mask:0xf bank_mask:0xf
    v_lshrrev_b32 v9, 31, v9
    v_sub_u32_dpp v10, v5, v5 row_ror:2 row_mask:0xf bank_mask:0xf
    v_lshrrev_b32 v10, 31, v10
    v_add3_u32 v8, v8, v9, v10
    v_sub_u32_dpp v9, v5, v5 row_ror:3 row_mask:0xf bank_mask:0xf
    v_lshrrev_b32 v9, 31, v9
    v_sub_u32_dpp v10, v5, v5 row_ror:4 row_mask:0xf bank_mask:0xf
    v_lshrrev_b32 v10, 31, v10
    v_add3_u32 v8, v8, v9, v10
    v_sub_u32_dpp v9, v5, v5 row_ror:5 row_mask:0xf bank_mask:0xf
    v_lshrrev_b32 v9, 31, v9
    v_sub_u32_dpp v10, v5, v5 row_ror:6 row_mask:0xf bank_mask:0xf
    v_lshrrev_b32 v10, 31, v10
    v_add3_u32 v8, v8, v9, v10
    v_sub_u32_dpp v9, v5, v5 row_ror:7 row_mask:0xf bank_mask:0xf
    v_lshrrev_b32 v9, 31, v9
    v_sub_u32_dpp v10, v5, v5 row_ror:8 row_mask:0xf bank_mask:0xf
    v_lshrrev_b32 v10, 31, v10
    v_add3_u32 v8, v8, v9, v10
    v_sub_u32_dpp v9, v5, v5 row_ror:9 row_mask:0xf bank_mask:0xf
    v_lshrrev_b32 v9, 31, v9
    v_sub_u32_dpp v10, v5, v5 row_ror:10 row_mask:0xf bank_mask:0xf
    v_lshrrev_b32 v10, 31, v10
    v_add3_u32 v8, v8, v9, v10
    v_sub_u32_dpp v9, v5, v5 row_ror:11 row_mask:0xf bank_mask:0xf
    v_lshrrev_b32 v9, 31, v9
    v_sub_u32_dpp v10, v5, v5 row_ror:12 row_mask:0xf bank_mask:0xf
    v_lshrrev_b32 v10, 31, v10
    v_add3_u32 v8, v8, v9, v10
    v_sub_u32_dpp v9, v5, v5 row_ror:13 row_mask:0xf bank_mask:0xf
    v_lshrrev_b32 v9, 31, v9
    v_sub_u32_dpp v10, v5, v5 row_ror:14 row_mask:0xf bank_mask:0xf
    v_lshrrev_b32 v10, 31, v10
    v_add3_u32 v8, v8, v9, v10
    v_sub_u32_dpp v9, v5, v5 row_ror:15 row_mask:0xf bank_mask:0xf
    v_lshrrev_b32 v9, 31, v9
    v_add_u32 v8, v8, v9
    v_readfirstlane_b32 s45, v3
    v_readfirstlane_b32 s47, v4
    v_readlane_b32 s61, v8, s4
    s_lshl_b32 s48, s4, 10
    v_add_u32 v3, s48, v2
    s_sub_u32 s49, s5, s61
    s_and_b32 s64, s49, 3
    s_lshl4_add_u32 s64, s64, s4
    s_and_b32 s49, s49, 12
    v_lshrrev_b32 v14, 4, v1
    v_add3_u32 v14, v14, s49, v8
    v_and_b32 v14, 15, v14
    v_mov_b32 v105, v6
    s_mov_b32 s54, 0x88788878
    s_mov_b32 s55, 0x88788878
    v_lshlrev_b32 v6, 2, v14
    v_lshrrev_b64 v[20:21], v6, s[54:55]
    v_and_b32 v104, 15, v20
    v_subrev_u32 v104, 8, v104
    s_waitcnt vmcnt(0)
    ds_read_b128 v[32:35], v2 offset:32768
    ds_read_b128 v[36:39], v2 offset:33792
    ds_read_b128 v[40:43], v2 offset:34816
    ds_read_b128 v[44:47], v2 offset:35840
    ds_read_b128 v[48:51], v2 offset:36864
    ds_read_b128 v[52:55], v2 offset:37888
    ds_read_b128 v[56:59], v2 offset:38912
    ds_read_b128 v[60:63], v2 offset:39936
    ds_read_b128 v[64:67], v2 offset:40960
    ds_read_b128 v[68:71], v2 offset:41984
    ds_read_b128 v[72:75], v2 offset:43008
    ds_read_b128 v[76:79], v2 offset:44032
    ds_read_b128 v[80:83], v2 offset:45056
    ds_read_b128 v[84:87], v2 offset:46080
    ds_read_b128 v[88:91], v2 offset:47104
    ds_read_b128 v[92:95], v2 offset:48128
    ds_read_b128 v[96:99], v3 offset:32768
    s_waitcnt lgkmcnt(15)
    v_cmpx_eq_u64 vcc, v[32:33], v[36:37]
    v_cmpx_eq_u64 vcc, v[34:35], v[38:39]
    s_waitcnt lgkmcnt(14)
    v_cmpx_eq_u64 vcc, v[32:33], v[40:41]
    v_cmpx_eq_u64 vcc, v[34:35], v[42:43]
    s_waitcnt lgkmcnt(13)
    v_cmpx_eq_u64 vcc, v[32:33], v[44:45]
    v_cmpx_eq_u64 vcc, v[34:35], v[46:47]
    s_waitcnt lgkmcnt(12)
    v_cmpx_eq_u64 vcc, v[32:33], v[48:49]
    v_cmpx_eq_u64 vcc, v[34:35], v[50:51]
    s_waitcnt lgkmcnt(11)
    v_cmpx_eq_u64 vcc, v[32:33], v[52:53]
    v_cmpx_eq_u64 vcc, v[34:35], v[54:55]
    s_waitcnt lgkmcnt(10)
    v_cmpx_eq_u64 vcc, v[32:33], v[56:57]
    v_cmpx_eq_u64 vcc, v[34:35], v[58:59]
    s_waitcnt lgkmcnt(9)
    v_cmpx_eq_u64 vcc, v[32:33], v[60:61]
    v_cmpx_eq_u64 vcc, v[34:35], v[62:63]
    s_waitcnt lgkmcnt(8)
    v_cmpx_eq_u64 vcc, v[32:33], v[64:65]
    v_cmpx_eq_u64 vcc, v[34:35], v[66:67]
    s_waitcnt lgkmcnt(7)
    v_cmpx_eq_u64 vcc, v[32:33], v[68:69]
    v_cmpx_eq_u64 vcc, v[34:35], v[70:71]
    s_waitcnt lgkmcnt(6)
    v_cmpx_eq_u64 vcc, v[32:33], v[72:73]
    v_cmpx_eq_u64 vcc, v[34:35], v[74:75]
    s_waitcnt lgkmcnt(5)
    v_cmpx_eq_u64 vcc, v[32:33], v[76:77]
    v_cmpx_eq_u64 vcc, v[34:35], v[78:79]
    s_waitcnt lgkmcnt(4)
    v_cmpx_eq_u64 vcc, v[32:33], v[80:81]
    v_cmpx_eq_u64 vcc, v[34:35], v[82:83]
    s_waitcnt lgkmcnt(3)
    v_cmpx_eq_u64 vcc, v[32:33], v[84:85]
    v_cmpx_eq_u64 vcc, v[34:35], v[86:87]
    s_waitcnt lgkmcnt(2)
    v_cmpx_eq_u64 vcc, v[32:33], v[88:89]
    v_cmpx_eq_u64 vcc, v[34:35], v[90:91]
    s_waitcnt lgkmcnt(1)
    v_cmpx_eq_u64 vcc, v[32:33], v[92:93]
    v_cmpx_eq_u64 vcc, v[34:35], v[94:95]
    s_ff0_i32_b64 s46, vcc
    s_mov_b64 exec, -1
    s_min_u32 s46, s46, s45
    s_mov_b32 s76, 0
    s_mul_i32 s65, s46, 15
    s_sub_u32 s65, s47, s65
    v_add_u32 v3, 1, v1
    s_mul_i32 s48, s65, 160
    s_lshr_b32 s48, s48, 12
    s_max_u32 s48, s48, 1
    v_mul_u32_u24 v4, s48, v3
    v_cmp_le_u32 vcc, s46, v4
    s_ff1_i32_b64 s48, vcc
    s_add_u32 s48, s48, 1
    s_min_u32 s48, s48, 8
    v_mul_u32_u24 v4, s48, v3
    v_cmp_le_u32 vcc, s46, v4
    s_ff1_i32_b64 s48, vcc
    s_add_u32 s81, s48, 1
    s_mul_i32 s48, s65, 110
    s_lshr_b32 s48, s48, 12
    s_max_u32 s48, s48, 1
    v_mul_u32_u24 v4, s48, v3
    v_cmp_le_u32 vcc, s46, v4
    s_ff1_i32_b64 s48, vcc
    s_add_u32 s48, s48, 1
    s_min_u32 s48, s48, 8
    v_mul_u32_u24 v4, s48, v3
    v_cmp_le_u32 vcc, s46, v4
    s_ff1_i32_b64 s48, vcc
    s_add_u32 s82, s48, 1
    s_and_b32 s48, s5, 3
    s_cmp_eq_u32 s48, 1
    s_cselect_b32 s48, s82, s81
    v_mul_u32_u24 v4, s48, v1
    v_cmp_gt_u32 vcc, s46, v4
    s_and_b32 s74, vcc_lo, 0xffff
    s_mov_b32 s75, 0
    v_and_b32 v3, 1, v8
    v_add_u32 v3, v3, v14
    v_and_b32 v3, 3, v3
    v_cmp_eq_u32 s[78:79], 1, v3
    v_mov_b32 v3, s81
    v_mov_b32 v6, s82
    v_cndmask_b32 v3, v3, v6, s[78:79]
    v_lshrrev_b32 v4, 1, v8
    v_and_b32 v5, 1, v14
    v_lshl_add_u32 v4, v5, 6, v4
    v_mul_u32_u24 v11, v3, v4
    s_and_b32 s67, s61, 1
    s_add_u32 s67, s67, s5
    s_lshr_b32 s66, s61, 1
    v_add_u32 v12, v3, v11
    v_min_u32 v11, s46, v11
    v_min_u32 v12, s46, v12
    v_sub_u32 v10, v12, v11
    v_readlane_b32 s59, v7, s4
    v_readlane_b32 s68, v11, s64
    v_readlane_b32 s69, v12, s64
    s_lshl_b32 s50, s66, 4
    s_add_u32 s50, s50, s67
    s_add_u32 s50, s50, 0x200
    s_cmp_eq_u32 s68, s69
    s_cselect_b32 s48, 1, s50
    v_mov_b32 v3, s48
    ds_write_b32 v26, v3 offset:62480
    s_cbranch_scc1 L_nopiece
    s_lshl_b32 s52, s67, 8
    v_mov_b32 v27, v1
    s_mov_b32 s70, 2096
    s_mov_b32 s71, 128
    s_mov_b32 s72, 512
    s_and_b32 s48, s67, 3
    s_cmp_eq_u32 s48, 1
    s_cselect_b32 s76, 0, 0
    s_waitcnt lgkmcnt(0)
    v_lshl_add_u32 v16, v96, 16, s52
    v_lshl_add_u32 v17, v97, 16, s52
    v_lshl_add_u32 v18, v98, 16, s52
    v_lshl_add_u32 v19, v99, 16, s52
    v_cmp_le_i32 s[54:55], s68, v27
    v_cmp_gt_i32 vcc, s69, v27
    s_and_b64 s[54:55], s[54:55], vcc
    s_sub_u32 s48, s58, s68
    v_add_u32 v24, s48, v27
    v_lshlrev_b32 v24, 5, v24
    s_mov_b64 exec, s[54:55]
    ds_write_b128 v24, v[16:19] offset:57344
    v_mov_b32 v20, s70
    v_cmp_le_i32 vcc, s76, v27
    v_or_b32 v4, 1048576, v20
    s_nop 0
    v_cndmask_b32 v20, v20, v4, vcc
    v_cmp_eq_u32 vcc, s68, v27
    v_or_b32 v4, s71, v20
    s_sub_u32 s48, s69, 1
    v_cndmask_b32 v20, v20, v4, vcc
    v_cmp_eq_u32 vcc, s48, v27
    v_or_b32 v4, s72, v20
    s_bcnt1_i32_b64 s48, s[54:55]
    v_cndmask_b32 v20, v20, v4, vcc
    s_add_u32 s58, s58, s48
    v_mov_b32 v21, v20
    v_mov_b32 v22, v20
    v_mov_b32 v23, v20
    s_waitcnt lgkmcnt(0)
    ds_write_b128 v24, v[20:23] offset:57360
    s_mov_b64 exec, -1
    s_lshl_b32 s49, s67, 9
    s_mov_b32 m0, 145920
    s_add_u32 s48, s49, 0
    buffer_load_dwordx4 v103, s[40:43], s48 offen lds
    s_mov_b32 m0, 146944
    s_add_u32 s48, s49, 16384
    buffer_load_dwordx4 v103, s[40:43], s48 offen lds
    s_mov_b32 m0, 147968
    s_add_u32 s48, s49, 32768
    buffer_load_dwordx4 v103, s[40:43], s48 offen lds
    s_mov_b32 m0, 148992
    s_add_u32 s48, s49, 49152
    buffer_load_dwordx4 v103, s[40:43], s48 offen lds
    s_mov_b32 m0, 150016
    s_add_u32 s48, s49, 65536
    buffer_load_dwordx4 v103, s[40:43], s48 offen lds
    s_mov_b32 m0, 151040
    s_add_u32 s48, s49, 81920
    buffer_load_dwordx4 v103, s[40:43], s48 offen lds
    s_mov_b32 m0, 152064
    s_add_u32 s48, s49, 98304
    buffer_load_dwordx4 v103, s[40:43], s48 offen lds
    s_mov_b32 m0, 153088
    s_add_u32 s48, s49, 114688
    buffer_load_dwordx4 v103, s[40:43], s48 offen lds
L_nopiece:
    v_mov_b32 v3, 13
    v_mov_b32 v4, 19
    v_cndmask_b32 v3, v3, v4, s[78:79]
    v_mad_u32_u24 v10, v10, v3, 8
    v_lshrrev_b32 v10, 4, v10
    s_mul_i32 s48, s65, 10
    s_lshr_b32 s48, s48, 12
    v_mul_i32_i24 v9, s48, v104
    v_subrev_u32 v15, s46, v7
    v_add_u32 v3, v15, v10
    v_sub_u32 v5, v3, v9
    v_and_b32 v6, 3, v14
    v_lshlrev_b32 v6, 3, v6
    v_add_u32_dpp v5, v5, v5 row_ror:8 row_mask:0xf bank_mask:0xf
    s_nop 1
    v_add_u32_dpp v5, v5, v5 row_ror:4 row_mask:0xf bank_mask:0xf
    s_nop 1
    v_add_u32_dpp v5, v5, v5 row_ror:2 row_mask:0xf bank_mask:0xf
    s_nop 1
    v_add_u32_dpp v5, v5, v5 row_ror:1 row_mask:0xf bank_mask:0xf
    s_nop 1
    v_readlane_b32 s49, v5, 0
    v_readlane_b32 s50, v5, 16
    v_readlane_b32 s51, v5, 32
    v_readlane_b32 s52, v5, 48
    s_mov_b32 s53, 0x20103000
    v_lshrrev_b32_e64 v6, v6, s53
    v_and_b32 v6, 0x30, v6
    v_add_u32 v6, v6, v105
    s_add_u32 s49, s49, s50
    s_add_u32 s51, s51, s52
    s_add_u32 s49, s49, s51
    s_add_u32 s49, s49, 0
    s_and_b32 s50, s49, 63
    s_lshr_b32 s49, s49, 6
    v_cmp_gt_u32 vcc, s50, v6
    v_add_u32 v9, s49, v9
    v_subrev_u32 v4, 4, v15
    v_addc_co_u32 v9, vcc, 0, v9, vcc
    v_med3_i32 v4, v4, 0, 32
    v_sub_u32 v28, v3, v9
    v_med3_i32 v28, v28, 0, v4
    v_sub_u32 v30, v9, v3
    v_max_i32 v30, 0, v30
    v_lshl_add_u32 v5, v30, 16, v28
    v_mov_b32 v4, v5
    s_nop 1
    v_add_u32_dpp v5, v5, v5 row_shr:1 row_mask:0xf bank_mask:0xf bound_ctrl:0
    s_nop 1
    v_add_u32_dpp v5, v5, v5 row_shr:2 row_mask:0xf bank_mask:0xf bound_ctrl:0
    s_nop 1
    v_add_u32_dpp v5, v5, v5 row_shr:4 row_mask:0xf bank_mask:0xf bound_ctrl:0
    s_nop 1
    v_add_u32_dpp v5, v5, v5 row_shr:8 row_mask:0xf bank_mask:0xf bound_ctrl:0
    s_nop 1
    v_add_u32_dpp v5, v5, v5 row_bcast:15 row_mask:0xa bank_mask:0xf
    s_nop 1
    v_add_u32_dpp v5, v5, v5 row_bcast:31 row_mask:0xc bank_mask:0xf
    s_nop 0
    v_readlane_b32 s51, v5, 63
    v_sub_u32 v5, v5, v4
    v_and_b32 v29, 0xffff, v5
    v_lshrrev_b32 v31, 16, v5
    s_lshr_b32 s50, s51, 16
    s_and_b32 s51, s51, 0xffff
    v_sub_u32 v4, s50, v29
    v_med3_i32 v28, v4, 0, v28
    v_sub_u32 v4, s51, v31
    v_med3_i32 v30, v4, 0, v30
    v_sub_u32 v13, v15, v28
    v_readlane_b32 s50, v31, s64
    v_readlane_b32 s51, v30, s64
    v_readlane_b32 s52, v29, s64
    v_readlane_b32 s53, v28, s64
    v_readlane_b32 s60, v13, s64
    s_add_u32 s51, s51, s50
    s_add_u32 s53, s53, s52
    v_max_u32 v100, s50, v29
    v_add_u32 v3, v29, v28
    v_min_u32 v101, s51, v3
    v_cmp_lt_u32 s[78:79], v100, v101
    v_sub_u32 v100, v100, v29
    v_sub_u32 v101, v101, v29
    v_max_u32 v3, s52, v31
    v_add_u32 v4, v31, v30
    v_min_u32 v4, s53, v4
    v_cmp_lt_u32 vcc, v3, v4
    v_subrev_u32 v3, s52, v3
    v_lshlrev_b32_e64 v3, v3, 1
    v_cndmask_b32 v9, 0, v3, vcc
    s_mov_b32 s71, 65664
    s_mov_b32 s76, 64
    s_cmp_eq_u64 s[78:79], 0
    s_cbranch_scc1 L_help_done
    s_mov_b32 m0, 53248
    s_nop 0
    s_lshl_b32 s48, s4, 13
    s_lshl_b32 s49, s5, 9
    s_add_u32 s48, s48, s49
    s_mov_b32 exec_hi, 0
    buffer_load_dwordx4 v102, s[40:43], s48 offen lds
    s_mov_b32 exec_hi, -1
L_help:
L_slot_1:
    ds_read_b32 v3, v26 offset:62476
    s_waitcnt lgkmcnt(0)
    v_readfirstlane_b32 s48, v3
    s_sub_u32 s48, s62, s48
    s_cmp_lt_u32 s48, 4
    s_cbranch_scc1 L_slot_1_ok
    s_add_u32 s48, s62, 1
    v_mov_b32 v3, s48
    s_waitcnt vmcnt(0)
    ds_write_b32 v26, v3 offset:62484
    s_setprio 0
    s_sleep 2
    s_sub_u32 s9, s9, 1
    s_cbranch_scc1 L_exit
    s_branch L_slot_1
L_slot_1_ok:
    s_ff1_i32_b64 s80, s[78:79]
    s_bitset0_b64 s[78:79], s80
    s_and_b32 s66, s80, 15
    s_lshl_b32 s49, s66, 10
    v_add_u32 v3, s49, v2
    ds_read_b128 v[16:19], v3 offset:32768
    v_readlane_b32 s67, v14, s80
    v_readlane_b32 s50, v100, s80
    v_readlane_b32 s51, v101, s80
    v_readlane_b32 s52, v7, s80
    v_readlane_b32 s53, v13, s80
    s_cmp_eq_u64 s[78:79], 0
    s_cselect_b32 s72, 131072, 0
    s_bitset1_b32 s72, 8
    s_and_b32 s48, s62, 7
    s_lshl_b32 s48, s48, 9
    s_add_u32 m0, s48, 49152
    s_nop 0
    s_lshl_b32 s48, s66, 13
    s_lshl_b32 s49, s67, 9
    s_add_u32 s48, s48, s49
    s_mov_b32 exec_hi, 0
    buffer_load_dwordx4 v102, s[40:43], s48 offen lds
    s_mov_b32 exec_hi, -1
    s_lshl_b32 s48, s67, 4
    s_add_u32 s48, s48, s66
    s_add_u32 s49, s50, 16
    v_mov_b32 v20, s48
    v_mov_b32 v21, s49
    s_and_b32 s48, s62, 3
    s_lshl_b32 s48, s48, 4
    v_mov_b32 v3, s48
    ds_write_b64 v3, v[20:21] offset:62496
    s_add_u32 s62, s62, 1
    s_add_u32 s68, s50, s53
    s_add_u32 s69, s51, s53
    s_sub_u32 s52, s52, 1
    v_sub_u32 v27, s52, v1
    s_lshr_b32 s48, s63, s66
    s_bitcmp1_b32 s48, 0
    s_cselect_b32 s70, 0, 16
    s_bitset1_b32 s70, 11
    s_lshl_b32 s48, s67, 8
    s_waitcnt lgkmcnt(0)
    v_lshl_add_u32 v16, v16, 16, s48
    v_lshl_add_u32 v17, v17, 16, s48
    v_lshl_add_u32 v18, v18, 16, s48
    v_lshl_add_u32 v19, v19, 16, s48
    v_cmp_le_i32 s[54:55], s68, v27
    v_cmp_gt_i32 vcc, s69, v27
    s_and_b64 s[54:55], s[54:55], vcc
    s_sub_u32 s48, s58, s68
    v_add_u32 v24, s48, v27
    v_lshlrev_b32 v24, 5, v24
    s_mov_b64 exec, s[54:55]
    ds_write_b128 v24, v[16:19] offset:57344
    v_mov_b32 v20, s70
    v_cmp_le_i32 vcc, s76, v27
    v_or_b32 v4, 1048576, v20
    s_nop 0
    v_cndmask_b32 v20, v20, v4, vcc
    v_cmp_eq_u32 vcc, s68, v27
    v_or_b32 v4, s71, v20
    s_sub_u32 s48, s69, 1
    v_cndmask_b32 v20, v20, v4, vcc
    v_cmp_eq_u32 vcc, s48, v27
    v_or_b32 v4, s72, v20
    s_bcnt1_i32_b64 s48, s[54:55]
    v_cndmask_b32 v20, v20, v4, vcc
    s_add_u32 s58, s58, s48
    v_mov_b32 v21, v20
    v_mov_b32 v22, v20
    v_mov_b32 v23, v20
    s_waitcnt lgkmcnt(0)
    ds_write_b128 v24, v[20:23] offset:57360
    s_mov_b64 exec, -1
    s_mov_b32 s71, 128
    s_cmp_lg_u64 s[78:79], 0
    s_cbranch_scc1 L_help
L_help_done:
L_slot_2:
    ds_read_b32 v3, v26 offset:62476
    s_waitcnt lgkmcnt(0)
    v_readfirstlane_b32 s48, v3
    s_sub_u32 s48, s62, s48
    s_cmp_lt_u32 s48, 4
    s_cbranch_scc1 L_slot_2_ok
    s_add_u32 s48, s62, 1
    v_mov_b32 v3, s48
    s_waitcnt vmcnt(0)
    ds_write_b32 v26, v3 offset:62484
    s_setprio 0
    s_sleep 2
    s_sub_u32 s9, s9, 1
    s_cbranch_scc1 L_exit
    s_branch L_slot_2
L_slot_2_ok:
    s_nop 1
    v_add_u32_dpp v9, v9, v9 row_shr:1 row_mask:0xf bank_mask:0xf bound_ctrl:0
    s_nop 1
    v_add_u32_dpp v9, v9, v9 row_shr:2 row_mask:0xf bank_mask:0xf bound_ctrl:0
    s_nop 1
    v_add_u32_dpp v9, v9, v9 row_shr:4 row_mask:0xf bank_mask:0xf bound_ctrl:0
    s_nop 1
    v_add_u32_dpp v9, v9, v9 row_shr:8 row_mask:0xf bank_mask:0xf bound_ctrl:0
    s_nop 1
    v_add_u32_dpp v9, v9, v9 row_bcast:15 row_mask:0xa bank_mask:0xf
    s_nop 1
    v_add_u32_dpp v9, v9, v9 row_bcast:31 row_mask:0xc bank_mask:0xf
    s_sub_u32 s52, s59, 1
    v_readlane_b32 s54, v9, 63
    v_sub_u32 v27, s52, v1
    s_mov_b32 s55, 0
    s_lshl_b64 s[54:55], s[54:55], 16
    s_or_b64 s[74:75], s[74:75], s[54:55]
    s_lshr_b32 s48, s63, s4
    s_bitcmp1_b32 s48, 0
    s_cselect_b32 s70, 0, 16
    s_bitset1_b32 s70, 11
    s_mov_b32 s71, 0
    s_mov_b32 s72, 256
    s_mov_b32 s68, 4
    s_mov_b32 s69, s60
    s_sub_i32 s76, s60, 3
    s_sub_i32 s49, s60, 4
    s_max_i32 s49, s49, 0
    s_add_u32 s49, s49, s58
    s_sub_i32 s49, s49, 5
    s_max_i32 s49, s49, 0
    v_mov_b32 v4, s49
    ds_write_b32 v26, v4 offset:62468
    s_lshl_b32 s48, s5, 4
    s_add_u32 s48, s48, s4
    v_mov_b32 v20, s48
    v_mov_b32 v21, 0
    v_mov_b32 v22, s74
    v_mov_b32 v23, s75
    s_and_b32 s48, s62, 3
    s_lshl_b32 s48, s48, 4
    v_mov_b32 v3, s48
    ds_write_b128 v3, v[20:23] offset:62496
    ds_write_b64 v26, v[22:23] offset:62488
    s_lshl_b32 s52, s5, 8
    s_waitcnt lgkmcnt(0)
    v_lshl_add_u32 v16, v96, 16, s52
    v_lshl_add_u32 v17, v97, 16, s52
    v_lshl_add_u32 v18, v98, 16, s52
    v_lshl_add_u32 v19, v99, 16, s52
    v_cmp_le_i32 s[54:55], s68, v27
    v_cmp_gt_i32 vcc, s69, v27
    s_and_b64 s[54:55], s[54:55], vcc
    s_sub_u32 s48, s58, s68
    v_add_u32 v24, s48, v27
    v_lshlrev_b32 v24, 5, v24
    s_mov_b64 exec, s[54:55]
    ds_write_b128 v24, v[16:19] offset:57344
    v_mov_b32 v20, s70
    v_cmp_le_i32 vcc, s76, v27
    v_or_b32 v4, 1048576, v20
    s_nop 0
    v_cndmask_b32 v20, v20, v4, vcc
    v_cmp_eq_u32 vcc, s68, v27
    v_or_b32 v4, s71, v20
    s_sub_u32 s48, s69, 1
    v_cndmask_b32 v20, v20, v4, vcc
    v_cmp_eq_u32 vcc, s48, v27
    v_or_b32 v4, s72, v20
    s_bcnt1_i32_b64 s48, s[54:55]
    v_cndmask_b32 v20, v20, v4, vcc
    s_add_u32 s58, s58, s48
    v_mov_b32 v21, v20
    v_mov_b32 v22, v20
    v_mov_b32 v23, v20
    s_waitcnt lgkmcnt(0)
    ds_write_b128 v24, v[20:23] offset:57360
    s_mov_b64 exec, -1
    s_cmp_gt_i32 s60, 4
    s_cbranch_scc1 L_sched_end
    s_lshl_b32 s48, s58, 5
    v_mov_b32 v24, s48
    v_mov_b32 v20, 2147483648
    v_mov_b32 v21, 2147483648
    v_mov_b32 v22, 2147483648
    v_mov_b32 v23, 2147483648
    s_mov_b64 exec, 1
    ds_write_b128 v24, v[20:23] offset:57344
    s_waitcnt lgkmcnt(0)
    v_mov_b32 v20, 1050944
    v_mov_b32 v21, 1050944
    v_mov_b32 v22, 1050944
    v_mov_b32 v23, 1050944
    ds_write_b128 v24, v[20:23] offset:57360
    s_mov_b64 exec, -1
    s_add_u32 s58, s58, 1
L_sched_end:
    s_lshl_b32 s48, s58, 5
    v_mov_b32 v24, s48
    v_mov_b32 v20, 2147483648
    v_mov_b32 v21, 2147483648
    v_mov_b32 v22, 2147483648
    v_mov_b32 v23, 2147483648
    s_mov_b64 exec, 1
    ds_write_b128 v24, v[20:23] offset:57344
    s_waitcnt lgkmcnt(0)
    v_mov_b32 v20, 1051712
    v_mov_b32 v21, 1051712
    v_mov_b32 v22, 1051712
    v_mov_b32 v23, 1051712
    ds_write_b128 v24, v[20:23] offset:57360
    s_mov_b64 exec, -1
    s_add_u32 s58, s58, 1
    s_add_u32 s48, s62, 2
    v_mov_b32 v4, s48
    ds_write_b32 v26, v4 offset:62472
    s_add_u32 s48, s62, 1
    v_mov_b32 v3, s48
    s_waitcnt vmcnt(0)
    ds_write_b32 v26, v3 offset:62484
    s_waitcnt lgkmcnt(0)
    s_endpgm
L_red:
    s_setprio 3
    v_lshlrev_b32 v2, 4, v1
    v_mov_b32 v3, 0
    s_memrealtime s[50:51]
    s_waitcnt lgkmcnt(0)
    s_mov_b32 s40, s28
    s_mov_b32 s41, s29
    s_mov_b32 s42, 256
    s_mov_b32 s43, 0x20000
    s_or_b32 s44, s50, 1
    s_mov_b32 s32, s30
    s_mov_b32 s33, s31
    s_mov_b32 s34, 570425344
    s_mov_b32 s35, 0x20000
    s_mov_b32 s36, s26
    s_mov_b32 s37, s27
    s_mov_b32 s38, 131072
    s_mov_b32 s39, 0x20000
    v_and_b32 v4, 3, v1
    v_lshlrev_b32 v4, 8, v4
    v_and_b32 v5, 15, v1
    v_lshrrev_b32 v8, 4, v1
    v_lshlrev_b32 v5, 4, v5
    v_lshl_add_u32 v9, v8, 2, v5
    v_mov_b32 v56, 0xff61b1e6
    v_mov_b32 v57, 0xff61b1e6
    v_mov_b32 v58, 0
    v_mov_b32 v59, 0
    v_mov_b32 v60, 0
    v_mov_b32 v61, 0
    v_mov_b32 v62, 0
    v_mov_b32 v63, 0
    s_mov_b32 s45, 0
    s_mov_b32 s71, 0
    v_mov_b32 v118, 0
    v_mov_b32 v112, 0
    v_mov_b32 v114, 0
    v_and_b32 v117, 31, v1
    v_lshlrev_b32 v117, 4, v117
    v_and_b32 v116, 32, v1
    s_mov_b32 s46, 0
    s_mov_b32 s47, 0
    s_mov_b32 s74, 0
    s_mov_b32 s72, 0
    s_mov_b32 s73, 0
    s_mov_b64 s[48:49], 0
    s_lshl_b32 s66, s5, 4
    s_add_u32 s66, s66, s4
    s_barrier
    s_setprio 0
    s_cmp_eq_u32 s2, 0
    s_cbranch_scc1 L_r_cas
L_r_wsch:
    ds_read_b32 v5, v4 offset:61440
    s_waitcnt lgkmcnt(0)
    v_cmp_le_u32 vcc, 2, v5
    s_cbranch_vccnz L_r_look
    s_nop 0
    s_sleep 4
    s_sub_u32 s9, s9, 1
    s_cbranch_scc1 L_exit
    s_branch L_r_wsch
L_r_look:
    s_nop 0
    s_load_dword s50, s[28:29], 0
    s_waitcnt lgkmcnt(0)
    s_cmp_lg_u32 s50, 0
    s_cbranch_scc1 L_r_tag
L_r_cas:
    v_mov_b32 v6, s44
    v_mov_b32 v7, 0
    s_mov_b64 exec, 1
    s_setprio 3
    buffer_atomic_cmpswap v[6:7], v3, s[40:43], 0 offen sc0
    s_setprio 0
    s_mov_b64 exec, -1
    s_waitcnt vmcnt(0)
    v_readfirstlane_b32 s50, v6
L_r_tag:
    s_cmp_eq_u32 s50, 0
    s_cselect_b32 s44, s44, s50
    v_mov_b32 v5, s44
    ds_write_b32 v3, v5 offset:62464
    s_mov_b32 s75, 2147483648
    s_mov_b32 s51, 0
    s_branch L_r_fast
L_rloop:
    ds_read_b32 v5, v4 offset:61440
    ds_read_b128 v[12:15], v3 offset:62464
    ds_read_b128 v[104:107], v3 offset:62480
    s_waitcnt lgkmcnt(0)
    v_bfe_u32 v7, v5, 8, 8
    v_cmp_ge_u32 vcc, s45, v7
    s_cbranch_vccz L_r_flush
    s_cmp_lg_u32 s46, 0
    s_cbranch_scc1 L_r_nosh
    v_readfirstlane_b32 s50, v104
    s_and_b32 s67, s50, 0xff
    s_cmp_eq_u32 s50, 1
    s_cselect_b32 s46, 1, 0
    v_and_b32 v7, 0x10000, v5
    v_cmp_eq_u32 vcc, 0, v7
    s_cbranch_vccz L_r_shared
L_r_nosh:
    s_cmp_eq_u32 s47, 1
    s_cbranch_scc1 L_r_retry
    s_cmp_eq_u32 s47, 2
    s_cbranch_scc1 L_r_noabs
    v_readfirstlane_b32 s56, v106
    v_readfirstlane_b32 s57, v107
    s_sub_u32 s74, s74, 1
    s_max_i32 s74, s74, 0
    s_cbranch_scc1 L_r_sleep
    v_and_b32 v7, 0xff, v5
    v_cmp_ge_u32 vcc, v7, v13
    s_cbranch_vccz L_r_sleep
    s_andn2_b64 s[56:57], s[56:57], s[48:49]
    s_cbranch_scc1 L_r_early
    s_branch L_r_sleep
L_r_noabs:
    v_readfirstlane_b32 s50, v14
    s_add_u32 s51, s45, 1
    s_cmp_eq_u32 s50, s51
    s_cbranch_scc0 L_r_sleep
    s_cmp_eq_u32 s46, 0
    s_cbranch_scc1 L_r_sleep
    s_cmp_eq_u32 s71, 0
    s_cbranch_scc1 L_red_done
L_r_sleep:
    s_cmp_eq_u32 s71, 0
    s_cbranch_scc1 L_r_nap
    v_readfirstlane_b32 s50, v14
    s_sub_u32 s50, s50, 2
    s_cmp_ge_u32 s45, s50
    s_cselect_b32 s50, s46, 0
    s_cmp_lg_u32 s50, 0
    s_cbranch_scc1 L_r_mark
L_r_nap:
    s_mov_b32 s64, 1
    s_cmp_eq_u32 s47, 0
    s_cbranch_scc1 L_r_arm
L_r_nap2:
    s_nop 0
    s_sleep 1
    s_sub_u32 s9, s9, 1
    s_cbranch_scc1 L_exit
    s_branch L_rloop
L_r_early:
    s_nop 0
    s_or_b64 s[48:49], s[48:49], s[56:57]
    s_mov_b32 s54, s66
    s_mov_b32 s64, 0
    s_branch L_absorb
L_absret0:
    s_andn2_b64 s[48:49], s[48:49], s[56:57]
    s_mov_b32 s74, 16
    s_branch L_r_sleep
L_r_shared:
    s_nop 0
    s_mov_b32 s46, 1
    v_and_b32 v7, 15, v1
    v_mul_u32_u24 v5, 1040, v7
    v_bfe_u32 v6, v1, 4, 1
    v_lshl_add_u32 v5, v6, 3, v5
    v_add_u32 v5, 80384, v5
    ds_read_b64 v[16:17], v5 offset:0
    ds_read_b64 v[18:19], v5 offset:16640
    ds_read_b64 v[20:21], v5 offset:33280
    ds_read_b64 v[22:23], v5 offset:49920
    v_lshlrev_b32 v11, 5, v7
    v_lshl_add_u32 v11, v6, 4, v11
    v_add_u32 v11, 145920, v11
    s_waitcnt lgkmcnt(0)
    v_max3_f32 v5, v16, v18, v20
    v_max_f32 v5, v5, v22
    v_sub_f32 v32, v16, v5
    v_sub_f32 v33, v18, v5
    v_sub_f32 v34, v20, v5
    v_sub_f32 v35, v22, v5
    v_exp_f32 v32, v32
    v_exp_f32 v33, v33
    v_exp_f32 v34, v34
    v_exp_f32 v35, v35
    s_nop 0
    v_mul_f32 v6, v32, v17
    v_fmac_f32 v6, v33, v19
    v_fmac_f32 v6, v34, v21
    v_fmac_f32 v6, v35, v23
    v_log_f32 v112, v6
    v_rcp_f32 v6, v6
    v_mov_b32 v113, s44
    v_add_f32 v112, v112, v5
    v_mul_f32 v32, v32, v6
    v_mul_f32 v33, v33, v6
    v_mul_f32 v34, v34, v6
    v_mul_f32 v35, v35, v6
    v_mov_b32 v114, v112
    v_mov_b32 v115, s44
    ds_write_b128 v11, v[32:35]
    v_permlane16_swap_b32 v112, v114
    v_add_u32 v10, 79360, v2
    v_mov_b32 v11, 145920
    s_mul_i32 s51, s67, 4352
    s_lshl_b32 s53, s67, 13
    s_mov_b32 s52, 0
    s_waitcnt lgkmcnt(0)
L_r_shl:
    ds_read_b128 v[32:35], v11 offset:0
    ds_read_b128 v[36:39], v11 offset:16
    ds_read_b128 v[16:19], v10 offset:0
    ds_read_b128 v[20:23], v10 offset:16640
    ds_read_b128 v[24:27], v10 offset:33280
    ds_read_b128 v[28:31], v10 offset:49920
    ds_read_b128 v[136:139], v11 offset:32
    ds_read_b128 v[140:143], v11 offset:48
    ds_read_b128 v[120:123], v10 offset:1040
    ds_read_b128 v[124:127], v10 offset:17680
    ds_read_b128 v[128:131], v10 offset:34320
    ds_read_b128 v[132:135], v10 offset:50960
    s_waitcnt lgkmcnt(6)
    v_mul_f32 v48, v32, v16
    v_mul_f32 v49, v36, v17
    v_mul_f32 v50, v32, v18
    v_mul_f32 v51, v36, v19
    v_fmac_f32 v48, v33, v20
    v_fmac_f32 v49, v37, v21
    v_fmac_f32 v50, v33, v22
    v_fmac_f32 v51, v37, v23
    v_fmac_f32 v48, v34, v24
    v_fmac_f32 v49, v38, v25
    v_fmac_f32 v50, v34, v26
    v_fmac_f32 v51, v38, v27
    v_fmac_f32 v48, v35, v28
    v_fmac_f32 v49, v39, v29
    v_fmac_f32 v50, v35, v30
    v_fmac_f32 v51, v39, v31
    v_cvt_pk_bf16_f32 v108, v48, v50
    v_cvt_pk_bf16_f32 v109, v49, v51
    s_waitcnt lgkmcnt(0)
    v_mul_f32 v48, v136, v120
    v_mul_f32 v49, v140, v121
    v_mul_f32 v50, v136, v122
    v_mul_f32 v51, v140, v123
    v_fmac_f32 v48, v137, v124
    v_fmac_f32 v49, v141, v125
    v_fmac_f32 v50, v137, v126
    v_fmac_f32 v51, v141, v127
    v_fmac_f32 v48, v138, v128
    v_fmac_f32 v49, v142, v129
    v_fmac_f32 v50, v138, v130
    v_fmac_f32 v51, v142, v131
    v_fmac_f32 v48, v139, v132
    v_fmac_f32 v49, v143, v133
    v_fmac_f32 v50, v139, v134
    v_fmac_f32 v51, v143, v135
    v_cvt_pk_bf16_f32 v110, v48, v50
    v_cvt_pk_bf16_f32 v111, v49, v51
    v_add_u32 v10, 2080, v10
    v_add_u32 v11, 64, v11
    v_permlane32_swap_b32 v108, v110
    v_permlane32_swap_b32 v109, v111
    s_setprio 3
    buffer_store_dwordx4 v[108:111], v2, s[32:35], s53 offen sc1
    s_setprio 0
    s_add_u32 s53, s53, 1024
    s_add_u32 s52, s52, 1
    s_cmp_lt_u32 s52, 8
    s_cbranch_scc1 L_r_shl
    s_add_u32 s51, s51, 8388608
    s_mov_b64 exec, 0xffff
    s_waitcnt vmcnt(0)
    s_setprio 3
    buffer_store_dwordx4 v[112:115], v2, s[32:35], s51 offen sc1
    s_setprio 0
    s_mov_b64 exec, -1
    s_and_b32 s50, s67, 15
    s_lshl_b32 s50, s50, 4
    s_sub_u32 s50, s50, s71
    v_add_u32 v5, s50, v1
    s_bfm_b64 exec, 16, s71
    v_mov_b32 v118, v5
    s_mov_b64 exec, -1
    s_add_u32 s71, s71, 16
    s_branch L_rloop
L_r_flush:
    s_nop 0
    s_mov_b32 s64, 0
L_r_arm:
    v_readfirstlane_b32 s50, v14
    v_readfirstlane_b32 s52, v106
    v_readfirstlane_b32 s53, v107
    s_sub_u32 s50, s50, 2
    s_cmp_eq_u32 s50, s45
    s_cbranch_scc0 L_r_noarm
    s_andn2_b64 s[52:53], s[52:53], s[48:49]
    s_cbranch_scc1 L_r_noarm
    s_cmp_eq_u32 s46, 0
    s_cbranch_scc1 L_r_noarm
    s_cmp_lg_u32 s71, 0
    s_cbranch_scc1 L_r_noarm
    s_lshl_b32 s75, s4, 13
    s_lshl_b32 s51, s5, 9
    s_add_u32 s75, s75, s51
    s_lshl_b32 s51, s45, 8
    s_add_u32 s51, s51, 0x100
L_r_fast:
    s_and_b32 s50, s45, 3
    s_mul_i32 s50, s50, 4160
    s_add_u32 s50, s50, 62720
    v_mov_b32 v11, s50
    v_add_u32 v10, s50, v2
L_r_aw:
    ds_read_u16 v5, v4 offset:61440
    s_sub_u32 s9, s9, 1
    s_cbranch_scc1 L_exit
    s_waitcnt lgkmcnt(0)
    v_cmp_gt_u32 vcc, s51, v5
    s_cbranch_vccnz L_r_aw
    ds_read_b128 v[32:35], v11 offset:1024
    ds_read_b128 v[36:39], v11 offset:2064
    ds_read_b128 v[40:43], v11 offset:3104
    ds_read_b128 v[44:47], v11 offset:4144
    ds_read_b128 v[16:19], v10 offset:0
    ds_read_b128 v[20:23], v10 offset:1040
    ds_read_b128 v[24:27], v10 offset:2080
    ds_read_b128 v[28:31], v10 offset:3120
    s_waitcnt lgkmcnt(4)
    v_max3_f32 v5, v32, v36, v40
    v_max3_f32 v5, v5, v44, v56
    v_max3_f32 v6, v34, v38, v42
    v_max3_f32 v6, v6, v46, v57
    v_sub_f32 v52, v56, v5
    v_sub_f32 v53, v57, v6
    v_sub_f32 v32, v32, v5
    v_sub_f32 v34, v34, v6
    v_sub_f32 v36, v36, v5
    v_sub_f32 v38, v38, v6
    v_sub_f32 v40, v40, v5
    v_sub_f32 v42, v42, v6
    v_sub_f32 v44, v44, v5
    v_sub_f32 v46, v46, v6
    v_exp_f32 v52, v52
    v_exp_f32 v53, v53
    v_exp_f32 v32, v32
    v_exp_f32 v34, v34
    v_exp_f32 v36, v36
    v_exp_f32 v38, v38
    v_exp_f32 v40, v40
    v_exp_f32 v42, v42
    v_exp_f32 v44, v44
    v_exp_f32 v46, v46
    v_mul_f32 v7, v52, v58
    v_mul_f32 v8, v53, v59
    v_fmac_f32 v7, v32, v33
    v_fmac_f32 v8, v34, v35
    v_fmac_f32 v7, v36, v37
    v_fmac_f32 v8, v38, v39
    v_fmac_f32 v7, v40, v41
    v_fmac_f32 v8, v42, v43
    v_fmac_f32 v7, v44, v45
    v_fmac_f32 v8, v46, v47
    v_mul_f32 v48, v52, v60
    v_mul_f32 v49, v53, v62
    v_mul_f32 v50, v52, v61
    v_mul_f32 v51, v53, v63
    v_rcp_f32 v7, v7
    v_rcp_f32 v8, v8
    s_waitcnt lgkmcnt(0)
    v_fmac_f32 v48, v32, v16
    v_fmac_f32 v49, v34, v17
    v_fmac_f32 v50, v32, v18
    v_fmac_f32 v51, v34, v19
    v_fmac_f32 v48, v36, v20
    v_fmac_f32 v49, v38, v21
    v_fmac_f32 v50, v36, v22
    v_fmac_f32 v51, v38, v23
    v_fmac_f32 v48, v40, v24
    v_fmac_f32 v49, v42, v25
    v_fmac_f32 v50, v40, v26
    v_fmac_f32 v51, v42, v27
    v_fmac_f32 v48, v44, v28
    v_fmac_f32 v49, v46, v29
    v_fmac_f32 v50, v44, v30
    v_fmac_f32 v51, v46, v31
    v_mul_f32 v48, v48, v7
    v_mul_f32 v49, v49, v8
    v_mul_f32 v50, v50, v7
    v_mul_f32 v51, v51, v8
    v_cvt_pk_bf16_f32 v5, v48, v50
    v_cvt_pk_bf16_f32 v6, v49, v51
    s_setprio 3
    buffer_store_dword v5, v9, s[36:39], s75 offen
    buffer_store_dword v6, v9, s[36:39], s75 offen offset:256
    s_setprio 0
    s_cmp_eq_u32 s75, 2147483648
    s_cbranch_scc1 L_rloop
    s_endpgm
L_r_noarm:
    s_cmp_lg_u32 s64, 0
    s_cbranch_scc1 L_r_nap2
    s_nop 0
    s_and_b32 s50, s45, 3
    s_lshl_b32 s51, s50, 4
    v_mov_b32 v5, s51
    ds_read_b128 v[104:107], v5 offset:62496
    s_mul_i32 s50, s50, 4160
    s_add_u32 s50, s50, 62720
    v_add_u32 v10, s50, v2
    v_mov_b32 v11, s50
    ds_read_b128 v[32:35], v11 offset:1024
    ds_read_b128 v[36:39], v11 offset:2064
    ds_read_b128 v[40:43], v11 offset:3104
    ds_read_b128 v[44:47], v11 offset:4144
    ds_read_b128 v[16:19], v10 offset:0
    ds_read_b128 v[20:23], v10 offset:1040
    ds_read_b128 v[24:27], v10 offset:2080
    ds_read_b128 v[28:31], v10 offset:3120
    s_waitcnt lgkmcnt(4)
    v_max3_f32 v5, v32, v36, v40
    v_max_f32 v5, v5, v44
    v_max3_f32 v6, v34, v38, v42
    v_max_f32 v6, v6, v46
    v_sub_f32 v32, v32, v5
    v_sub_f32 v34, v34, v6
    v_sub_f32 v36, v36, v5
    v_sub_f32 v38, v38, v6
    v_sub_f32 v40, v40, v5
    v_sub_f32 v42, v42, v6
    v_sub_f32 v44, v44, v5
    v_sub_f32 v46, v46, v6
    v_exp_f32 v32, v32
    v_exp_f32 v34, v34
    v_exp_f32 v36, v36
    v_exp_f32 v38, v38
    v_exp_f32 v40, v40
    v_exp_f32 v42, v42
    v_exp_f32 v44, v44
    v_exp_f32 v46, v46
    s_nop 0
    v_mul_f32 v7, v32, v33
    v_mul_f32 v8, v34, v35
    v_fmac_f32 v7, v36, v37
    v_fmac_f32 v8, v38, v39
    v_fmac_f32 v7, v40, v41
    v_fmac_f32 v8, v42, v43
    v_fmac_f32 v7, v44, v45
    v_fmac_f32 v8, v46, v47
    s_waitcnt lgkmcnt(0)
    v_mul_f32 v48, v32, v16
    v_mul_f32 v52, v34, v17
    v_mul_f32 v49, v32, v18
    v_mul_f32 v53, v34, v19
    v_fmac_f32 v48, v36, v20
    v_fmac_f32 v52, v38, v21
    v_fmac_f32 v49, v36, v22
    v_fmac_f32 v53, v38, v23
    v_fmac_f32 v48, v40, v24
    v_fmac_f32 v52, v42, v25
    v_fmac_f32 v49, v40, v26
    v_fmac_f32 v53, v42, v27
    v_fmac_f32 v48, v44, v28
    v_fmac_f32 v52, v46, v29
    v_fmac_f32 v49, v44, v30
    v_fmac_f32 v53, v46, v31
    v_log_f32 v50, v7
    v_log_f32 v54, v8
    v_rcp_f32 v7, v7
    v_rcp_f32 v8, v8
    s_nop 0
    v_add_f32 v50, v50, v5
    v_add_f32 v54, v54, v6
    v_mul_f32 v48, v48, v7
    v_mul_f32 v49, v49, v7
    v_mul_f32 v52, v52, v8
    v_mul_f32 v53, v53, v8
    s_add_u32 s45, s45, 1
    v_mov_b32 v5, s45
    ds_write_b32 v3, v5 offset:62476
    v_readfirstlane_b32 s50, v105
    v_readfirstlane_b32 s51, v104
    s_cmp_eq_u32 s50, 0
    s_cbranch_scc1 L_r_own
    s_lshl_b32 s53, s50, 8
    s_add_u32 s53, s53, s51
    v_cvt_pk_bf16_f32 v108, v48, v49
    v_cvt_pk_bf16_f32 v109, v52, v53
    v_mov_b32 v110, v108
    v_mov_b32 v111, v109
    s_lshl_b32 s50, s53, 9
    v_mov_b32 v52, v50
    v_permlane32_swap_b32 v108, v110
    v_permlane32_swap_b32 v109, v111
    v_mov_b32 v53, s44
    v_mov_b32 v55, s44
    s_mov_b32 exec_hi, 0
    s_setprio 3
    buffer_store_dwordx4 v[108:111], v2, s[32:35], s50 offen sc1
    s_setprio 0
    s_lshl_b32 s50, s53, 7
    s_add_u32 s50, s50, 12582912
    s_mov_b64 exec, 0xff
    s_waitcnt vmcnt(0)
    s_setprio 3
    buffer_store_dwordx4 v[52:55], v2, s[32:35], s50 offen sc1
    s_setprio 0
    s_mov_b64 exec, -1
    s_mov_b32 m0, s71
    s_add_u32 s71, s71, 1
    v_writelane_b32 v118, s51, m0
    s_cmp_ge_u32 s71, 40
    s_cbranch_scc0 L_rloop
L_r_mark:
    v_mul_u32_u24 v5, 4352, v118
    s_mov_b32 s53, 16777244
    s_bfm_b64 exec, s71, 0
    s_waitcnt vmcnt(0)
    s_setprio 3
    buffer_load_dword v6, v5, s[32:35], s53 offen sc1
    s_setprio 0
    s_mov_b32 s71, 0
    s_waitcnt vmcnt(0)
    v_cmp_eq_u32 vcc, s44, v6
    s_mov_b64 exec, -1
    s_mov_b64 s[92:93], vcc
L_r_mlate:
    s_cmp_eq_u64 s[92:93], 0
    s_cbranch_scc1 L_rloop
    s_ff1_i32_b64 s50, s[92:93]
    s_bitset0_b64 s[92:93], s50
    v_readlane_b32 s54, v118, s50
    s_mov_b32 s65, 0
    s_branch L_late
L_lateret0:
    s_branch L_r_mlate
L_r_own:
    v_readfirstlane_b32 s56, v106
    v_readfirstlane_b32 s57, v107
    s_mov_b32 s47, 1
    s_andn2_b64 s[56:57], s[56:57], s[48:49]
    v_max_f32 v5, v56, v50
    v_max_f32 v6, v57, v54
    v_sub_f32 v7, v56, v5
    v_sub_f32 v50, v50, v5
    v_sub_f32 v8, v57, v6
    v_sub_f32 v54, v54, v6
    v_exp_f32 v7, v7
    v_exp_f32 v50, v50
    v_exp_f32 v8, v8
    v_exp_f32 v54, v54
    v_mov_b32 v56, v5
    v_mov_b32 v57, v6
    v_fma_f32 v58, v58, v7, v50
    v_mul_f32 v60, v60, v7
    v_mul_f32 v61, v61, v7
    v_fmac_f32 v60, v50, v48
    v_fmac_f32 v61, v50, v49
    v_fma_f32 v59, v59, v8, v54
    v_mul_f32 v62, v62, v8
    v_mul_f32 v63, v63, v8
    v_fmac_f32 v62, v54, v52
    v_fmac_f32 v63, v54, v53
L_r_retry:
    s_nop 0
    s_mov_b32 s54, s66
    s_mov_b32 s64, 1
    s_branch L_absorb
L_absret1:
    s_cmp_eq_u64 s[56:57], 0
    s_cbranch_scc1 L_r_fin
    ds_read_b32 v5, v3 offset:62472
    s_add_u32 s51, s45, 1
    s_waitcnt lgkmcnt(0)
    v_readfirstlane_b32 s50, v5
    s_cmp_eq_u32 s50, s51
    s_cbranch_scc0 L_r_sleep
    s_cmp_eq_u32 s46, 0
    s_cbranch_scc1 L_r_sleep
    s_add_u32 s72, s72, 1
    s_cmp_lt_u32 s72, 24
    s_cbranch_scc1 L_r_sleep
    s_add_u32 s73, s73, 1
    v_log_f32 v50, v58
    v_log_f32 v54, v59
    v_rcp_f32 v7, v58
    v_rcp_f32 v8, v59
    s_nop 0
    v_add_f32 v50, v50, v56
    v_add_f32 v54, v54, v57
    v_mul_f32 v48, v60, v7
    v_mul_f32 v49, v61, v7
    v_mul_f32 v52, v62, v8
    v_mul_f32 v53, v63, v8
    s_add_u32 s52, s66, 12288
    s_mul_i32 s53, s66, 4352
    s_add_u32 s53, s53, 16777232
    v_cvt_pk_bf16_f32 v108, v48, v49
    v_cvt_pk_bf16_f32 v109, v52, v53
    v_mov_b32 v110, v108
    v_mov_b32 v111, v109
    s_lshl_b32 s50, s52, 9
    v_mov_b32 v52, v50
    v_permlane32_swap_b32 v108, v110
    v_permlane32_swap_b32 v109, v111
    v_mov_b32 v53, s44
    v_mov_b32 v55, s44
    s_mov_b32 exec_hi, 0
    s_setprio 3
    buffer_store_dwordx4 v[108:111], v2, s[32:35], s50 offen sc1
    s_setprio 0
    s_lshl_b32 s50, s52, 7
    s_add_u32 s50, s50, 12582912
    s_mov_b64 exec, 0xff
    s_waitcnt vmcnt(0)
    s_setprio 3
    buffer_store_dwordx4 v[52:55], v2, s[32:35], s50 offen sc1
    s_setprio 0
    s_mov_b64 exec, -1
    v_mov_b32 v104, s56
    v_mov_b32 v105, s57
    v_mov_b32 v106, 0
    v_mov_b32 v107, s44
    s_waitcnt vmcnt(0)
    s_mov_b64 exec, 1
    s_setprio 3
    buffer_store_dwordx4 v[104:107], v3, s[32:35], s53 offen sc1
    s_setprio 0
    s_mov_b64 exec, -1
    s_waitcnt vmcnt(0)
    s_mov_b32 s64, 2
    s_branch L_absorb
L_absret2:
    s_mov_b32 s47, 2
    s_cmp_eq_u64 s[56:57], 0
    s_cbranch_scc0 L_rloop
L_r_fin:
    s_mov_b32 s47, 2
    v_rcp_f32 v5, v58
    v_rcp_f32 v6, v59
    s_and_b32 s50, s54, 15
    s_lshl_b32 s50, s50, 13
    s_lshr_b32 s51, s54, 4
    s_lshl_b32 s51, s51, 9
    s_add_u32 s50, s50, s51
    v_mul_f32 v60, v60, v5
    v_mul_f32 v61, v61, v5
    v_mul_f32 v62, v62, v6
    v_mul_f32 v63, v63, v6
    v_cvt_pk_bf16_f32 v5, v60, v61
    v_cvt_pk_bf16_f32 v6, v62, v63
    s_setprio 3
    buffer_store_dword v5, v9, s[36:39], s50 offen
    buffer_store_dword v6, v9, s[36:39], s50 offen offset:256
    s_setprio 0
    s_branch L_r_noabs
L_late:
    s_mov_b64 s[68:69], s[56:57]
    v_mov_b32 v64, v56
    v_mov_b32 v65, v57
    v_mov_b32 v66, v58
    v_mov_b32 v67, v59
    v_mov_b32 v68, v60
    v_mov_b32 v69, v61
    v_mov_b32 v70, v62
    v_mov_b32 v71, v63
    s_mul_i32 s53, s54, 4352
    s_add_u32 s53, s53, 16777232
    s_setprio 3
    buffer_load_dwordx4 v[104:107], v3, s[32:35], s53 offen sc1
    s_setprio 0
    v_mov_b32 v56, 0xff61b1e6
    v_mov_b32 v57, 0xff61b1e6
    v_mov_b32 v58, 0
    v_mov_b32 v59, 0
    v_mov_b32 v60, 0
    v_mov_b32 v61, 0
    v_mov_b32 v62, 0
    v_mov_b32 v63, 0
    s_waitcnt vmcnt(0)
    v_readfirstlane_b32 s56, v104
    v_readfirstlane_b32 s57, v105
    s_bitset1_b32 s57, 16
    s_mov_b32 s64, 3
    s_branch L_absorb
L_absret3:
    s_cmp_eq_u64 s[56:57], 0
    s_cbranch_scc0 L_late_out
    v_rcp_f32 v5, v58
    v_rcp_f32 v6, v59
    s_and_b32 s50, s54, 15
    s_lshl_b32 s50, s50, 13
    s_lshr_b32 s51, s54, 4
    s_lshl_b32 s51, s51, 9
    s_add_u32 s50, s50, s51
    v_mul_f32 v60, v60, v5
    v_mul_f32 v61, v61, v5
    v_mul_f32 v62, v62, v6
    v_mul_f32 v63, v63, v6
    v_cvt_pk_bf16_f32 v5, v60, v61
    v_cvt_pk_bf16_f32 v6, v62, v63
    s_setprio 3
    buffer_store_dword v5, v9, s[36:39], s50 offen
    buffer_store_dword v6, v9, s[36:39], s50 offen offset:256
    s_setprio 0
L_late_out:
    s_mov_b64 s[56:57], s[68:69]
    v_mov_b32 v56, v64
    v_mov_b32 v57, v65
    v_mov_b32 v58, v66
    v_mov_b32 v59, v67
    v_mov_b32 v60, v68
    v_mov_b32 v61, v69
    v_mov_b32 v62, v70
    v_mov_b32 v63, v71
    s_branch L_lateret0
L_absorb:
    s_cmp_eq_u64 s[56:57], 0
    s_cbranch_scc1 L_abs_done
    s_lshr_b32 s53, s54, 4
    s_mul_i32 s53, s53, 4096
    s_lshl4_add_u32 s53, s54, s53
    s_add_u32 s53, s53, 8388608
    s_lshl_b32 s52, s54, 7
    s_add_u32 s52, s52, 12582912
    s_mov_b64 s[10:11], s[56:57]
    s_mov_b64 s[58:59], 0
L_abs_hdr:
    s_ff1_i32_b64 s60, s[10:11]
    s_max_i32 s51, s60, 0
    s_bitset0_b64 s[10:11], s51
    s_mul_i32 s50, s51, 69632
    s_add_u32 s50, s50, s53
    s_lshl_b32 s76, s51, 15
    s_add_u32 s76, s76, s52
    s_cmp_lt_u32 s51, 16
    s_cselect_b32 s50, s50, s76
    s_load_dwordx4 s[76:79], s[30:31], s50 glc
    s_ff1_i32_b64 s61, s[10:11]
    s_max_i32 s51, s61, 0
    s_bitset0_b64 s[10:11], s51
    s_mul_i32 s50, s51, 69632
    s_add_u32 s50, s50, s53
    s_lshl_b32 s80, s51, 15
    s_add_u32 s80, s80, s52
    s_cmp_lt_u32 s51, 16
    s_cselect_b32 s50, s50, s80
    s_load_dwordx4 s[80:83], s[30:31], s50 glc
    s_ff1_i32_b64 s62, s[10:11]
    s_max_i32 s51, s62, 0
    s_bitset0_b64 s[10:11], s51
    s_mul_i32 s50, s51, 69632
    s_add_u32 s50, s50, s53
    s_lshl_b32 s84, s51, 15
    s_add_u32 s84, s84, s52
    s_cmp_lt_u32 s51, 16
    s_cselect_b32 s50, s50, s84
    s_load_dwordx4 s[84:87], s[30:31], s50 glc
    s_ff1_i32_b64 s63, s[10:11]
    s_max_i32 s51, s63, 0
    s_bitset0_b64 s[10:11], s51
    s_mul_i32 s50, s51, 69632
    s_add_u32 s50, s50, s53
    s_lshl_b32 s88, s51, 15
    s_add_u32 s88, s88, s52
    s_cmp_lt_u32 s51, 16
    s_cselect_b32 s50, s50, s88
    s_load_dwordx4 s[88:91], s[30:31], s50 glc
    s_waitcnt lgkmcnt(0)
    s_cmp_lt_i32 s60, 0
    s_cbranch_scc1 L_abs_hend
    s_xor_b32 s50, s77, s44
    s_xor_b32 s51, s79, s44
    s_or_b32 s50, s50, s51
    s_cbranch_scc1 L_abs_hs0
    s_mov_b32 m0, s60
    s_bitset1_b64 s[58:59], s60
    v_writelane_b32 v112, s76, m0
    v_writelane_b32 v114, s78, m0
L_abs_hs0:
    s_cmp_lt_i32 s61, 0
    s_cbranch_scc1 L_abs_hend
    s_xor_b32 s50, s81, s44
    s_xor_b32 s51, s83, s44
    s_or_b32 s50, s50, s51
    s_cbranch_scc1 L_abs_hs1
    s_mov_b32 m0, s61
    s_bitset1_b64 s[58:59], s61
    v_writelane_b32 v112, s80, m0
    v_writelane_b32 v114, s82, m0
L_abs_hs1:
    s_cmp_lt_i32 s62, 0
    s_cbranch_scc1 L_abs_hend
    s_xor_b32 s50, s85, s44
    s_xor_b32 s51, s87, s44
    s_or_b32 s50, s50, s51
    s_cbranch_scc1 L_abs_hs2
    s_mov_b32 m0, s62
    s_bitset1_b64 s[58:59], s62
    v_writelane_b32 v112, s84, m0
    v_writelane_b32 v114, s86, m0
L_abs_hs2:
    s_cmp_lt_i32 s63, 0
    s_cbranch_scc1 L_abs_hend
    s_xor_b32 s50, s89, s44
    s_xor_b32 s51, s91, s44
    s_or_b32 s50, s50, s51
    s_cbranch_scc1 L_abs_hs3
    s_mov_b32 m0, s63
    s_bitset1_b64 s[58:59], s63
    v_writelane_b32 v112, s88, m0
    v_writelane_b32 v114, s90, m0
L_abs_hs3:
    s_cmp_lg_u64 s[10:11], 0
    s_cbranch_scc1 L_abs_hdr
L_abs_hend:
    s_andn2_b64 s[56:57], s[56:57], s[58:59]
    s_lshl_b32 s53, s54, 9
L_abs_loop:
    s_cmp_eq_u64 s[58:59], 0
    s_cbranch_scc1 L_abs_done
    s_ff1_i32_b64 s76, s[58:59]
    s_cmp_lt_i32 s76, 0
    s_cbranch_scc1 L_abs_go
    s_bitset0_b64 s[58:59], s76
    s_ff1_i32_b64 s77, s[58:59]
    s_max_i32 s51, s77, s76
    s_bitset0_b64 s[58:59], s51
    s_sub_u32 s51, s51, s76
    s_lshl_b32 s51, s51, 12
    s_lshl_b32 s50, s76, 17
    s_add_u32 s50, s50, s53
    v_mad_u32_u24 v5, v116, s51, v117
    s_setprio 3
    buffer_load_dwordx4 v[72:75], v5, s[32:35], s50 offen sc1
    s_setprio 0
    s_ff1_i32_b64 s78, s[58:59]
    s_cmp_lt_i32 s78, 0
    s_cbranch_scc1 L_abs_go
    s_bitset0_b64 s[58:59], s78
    s_ff1_i32_b64 s79, s[58:59]
    s_max_i32 s51, s79, s78
    s_bitset0_b64 s[58:59], s51
    s_sub_u32 s51, s51, s78
    s_lshl_b32 s51, s51, 12
    s_lshl_b32 s50, s78, 17
    s_add_u32 s50, s50, s53
    v_mad_u32_u24 v5, v116, s51, v117
    s_setprio 3
    buffer_load_dwordx4 v[76:79], v5, s[32:35], s50 offen sc1
    s_setprio 0
    s_ff1_i32_b64 s80, s[58:59]
    s_cmp_lt_i32 s80, 0
    s_cbranch_scc1 L_abs_go
    s_bitset0_b64 s[58:59], s80
    s_ff1_i32_b64 s81, s[58:59]
    s_max_i32 s51, s81, s80
    s_bitset0_b64 s[58:59], s51
    s_sub_u32 s51, s51, s80
    s_lshl_b32 s51, s51, 12
    s_lshl_b32 s50, s80, 17
    s_add_u32 s50, s50, s53
    v_mad_u32_u24 v5, v116, s51, v117
    s_setprio 3
    buffer_load_dwordx4 v[80:83], v5, s[32:35], s50 offen sc1
    s_setprio 0
    s_ff1_i32_b64 s82, s[58:59]
    s_cmp_lt_i32 s82, 0
    s_cbranch_scc1 L_abs_go
    s_bitset0_b64 s[58:59], s82
    s_ff1_i32_b64 s83, s[58:59]
    s_max_i32 s51, s83, s82
    s_bitset0_b64 s[58:59], s51
    s_sub_u32 s51, s51, s82
    s_lshl_b32 s51, s51, 12
    s_lshl_b32 s50, s82, 17
    s_add_u32 s50, s50, s53
    v_mad_u32_u24 v5, v116, s51, v117
    s_setprio 3
    buffer_load_dwordx4 v[84:87], v5, s[32:35], s50 offen sc1
    s_setprio 0
L_abs_go:
    s_waitcnt vmcnt(0)
    v_permlane32_swap_b32 v72, v74
    v_permlane32_swap_b32 v73, v75
    v_permlane32_swap_b32 v76, v78
    v_permlane32_swap_b32 v77, v79
    v_permlane32_swap_b32 v80, v82
    v_permlane32_swap_b32 v81, v83
    v_permlane32_swap_b32 v84, v86
    v_permlane32_swap_b32 v85, v87
L_abs_f:
    v_readlane_b32 s50, v112, s76
    v_readlane_b32 s51, v114, s76
    v_lshlrev_b32 v48, 16, v72
    v_and_b32 v49, 0xffff0000, v72
    v_lshlrev_b32 v52, 16, v73
    v_and_b32 v53, 0xffff0000, v73
    v_mov_b32 v50, s50
    v_mov_b32 v54, s51
    v_max_f32 v5, v56, v50
    v_max_f32 v6, v57, v54
    v_sub_f32 v7, v56, v5
    v_sub_f32 v50, v50, v5
    v_sub_f32 v8, v57, v6
    v_sub_f32 v54, v54, v6
    v_exp_f32 v7, v7
    v_exp_f32 v50, v50
    v_exp_f32 v8, v8
    v_exp_f32 v54, v54
    v_mov_b32 v56, v5
    v_mov_b32 v57, v6
    v_fma_f32 v58, v58, v7, v50
    v_mul_f32 v60, v60, v7
    v_mul_f32 v61, v61, v7
    v_fmac_f32 v60, v50, v48
    v_fmac_f32 v61, v50, v49
    v_fma_f32 v59, v59, v8, v54
    v_mul_f32 v62, v62, v8
    v_mul_f32 v63, v63, v8
    v_fmac_f32 v62, v54, v52
    v_fmac_f32 v63, v54, v53
    s_mov_b32 s76, s77
    v_mov_b32 v72, v74
    v_mov_b32 v73, v75
    s_mov_b32 s77, s78
    v_mov_b32 v74, v76
    v_mov_b32 v75, v77
    s_mov_b32 s78, s79
    v_mov_b32 v76, v78
    v_mov_b32 v77, v79
    s_mov_b32 s79, s80
    v_mov_b32 v78, v80
    v_mov_b32 v79, v81
    s_mov_b32 s80, s81
    v_mov_b32 v80, v82
    v_mov_b32 v81, v83
    s_mov_b32 s81, s82
    v_mov_b32 v82, v84
    v_mov_b32 v83, v85
    s_mov_b32 s82, s83
    v_mov_b32 v84, v86
    v_mov_b32 v85, v87
    s_mov_b32 s83, -1
    s_cmp_ge_i32 s76, 0
    s_cbranch_scc1 L_abs_f
    s_branch L_abs_loop
L_abs_done:
    s_cmp_eq_u32 s64, 0
    s_cbranch_scc1 L_absret0
    s_cmp_eq_u32 s64, 1
    s_cbranch_scc1 L_absret1
    s_cmp_eq_u32 s64, 2
    s_cbranch_scc1 L_absret2
    s_branch L_absret3
L_red_done:
    s_endpgm
L_exit:
    s_endpgm
.section .rodata,"a"
.p2align 6
.amdhsa_kernel standalone__paged_block_table_kv_radixattention__sampling_kernel
  .amdhsa_next_free_vgpr 240
  .amdhsa_next_free_sgpr 102
  .amdhsa_accum_offset 240
  .amdhsa_group_segment_fixed_size 0
  .amdhsa_kernarg_size 64
  .amdhsa_user_sgpr_count 2
  .amdhsa_user_sgpr_kernarg_segment_ptr 1
  .amdhsa_system_sgpr_workgroup_id_x 1
.end_amdhsa_kernel
```
